```python
import torch

def _softmax(x, axis=-1):
    return torch.softmax(x, dim=axis)
def _gelu(x):
    return torch.nn.functional.gelu(x, approximate="tanh")
def _silu(x):
    return torch.nn.functional.silu(x)
def _sigmoid(x):
    return torch.sigmoid(x)
def _layernorm(x, axis=-1, eps=1e-5):
    m = x.mean(dim=axis, keepdim=True)
    v = x.var(dim=axis, keepdim=True, unbiased=False)
    return (x - m) / torch.sqrt(v + eps)
def _scatter_add(tgt, idx, src, axis=0):
    return tgt.clone().index_add_(axis, idx, src)
def _segment_sum(src, seg, n):
    out = torch.zeros((n,) + src.shape[1:], dtype=src.dtype)
    return out.index_add_(0, seg, src)
def _pad(x, pw):
    flat = tuple(v for pair in reversed(pw) for v in pair)
    return torch.nn.functional.pad(x, flat)

kernel_name = 'recurrent_scan__gqa_block_cached__dense_activation_relu__decode'

def setup_inputs():

    _w = (lambda a: (lambda t: t.to(torch.bfloat16) if t.is_floating_point() else t)(torch.as_tensor(a)))
    def _A_setup():
        B, Sq, D = 8, 1, 448
        Hq, Hkv, Sk, Dh = 16, 8, 4096, 256
        assert Hq % Hkv == 0, (Hq, Hkv)
        return {
            "x": _w((lambda *s: torch.randn(*s, dtype=torch.bfloat16) * 0.05)(B, Sq, D)),
            "k_cache": _w((lambda *s: torch.randn(*s, dtype=torch.bfloat16) * 0.8)(B, Hkv, Sk, Dh)),
            "v_cache": _w((lambda *s: torch.randn(*s, dtype=torch.bfloat16) * 0.8)(B, Hkv, Sk, Dh)),
            "wq": _w((lambda *s: torch.randn(*s, dtype=torch.bfloat16) * 0.8)(D, Hq * Dh) * (D ** -0.5)),
            "wo": _w((lambda *s: torch.randn(*s, dtype=torch.bfloat16) * 0.8)(Hq * Dh, D) * ((Hq * Dh) ** -0.5)),
        }
    _A_in = _A_setup()

    def _B_setup():
        B, S, D, Dff = 8, 1, 448, 1792
        return {
            "x": _w((lambda *s: torch.randn(*s, dtype=torch.bfloat16) * 0.05)(B, S, D)),
            "w1": _w((lambda *s: torch.randn(*s, dtype=torch.bfloat16) * 0.2)(D, Dff)),
            "w2": _w((lambda *s: torch.randn(*s, dtype=torch.bfloat16) * 0.2)(Dff, D)),
        }
    _B_in = _B_setup()

    return {
        "A_x": _A_in["x"],
        "A_k_cache": _A_in["k_cache"],
        "A_v_cache": _A_in["v_cache"],
        "A_wq": _A_in["wq"],
        "A_wo": _A_in["wo"],
        "B_x": _B_in["x"],
        "B_w1": _B_in["w1"],
        "B_w2": _B_in["w2"],
    }

def reference(A_x, A_k_cache, A_v_cache, A_wq, A_wo, B_x, B_w1, B_w2):
    def _A_ref(x, k_cache, v_cache, wq, wo):
        B, Sq, D = x.shape
        Hq, Dh = 16, 256
        Hkv = k_cache.shape[1]
        rep = Hq // Hkv
        q = (lambda x, *d: x.permute(*d))((x @ wq).reshape(B, Sq, Hq, Dh), 0, 2, 1, 3)
        k = (lambda x, n, axis: torch.repeat_interleave(x, n, dim=axis))(k_cache, rep, axis=1)
        v = (lambda x, n, axis: torch.repeat_interleave(x, n, dim=axis))(v_cache, rep, axis=1)
        scores = torch.einsum("bhqd,bhkd->bhqk", q, k) * (Dh ** -0.5)
        p = _softmax(scores, axis=-1)
        o = torch.einsum("bhqk,bhkd->bhqd", p, v)
        return (lambda x, *d: x.permute(*d))(o, 0, 2, 1, 3).reshape(B, Sq, Hq * Dh) @ wo

    def _B_ref(x, w1, w2):
        h = torch.einsum("bsd,df->bsf", x, w1)
        zero = torch.zeros_like(h)
        h = torch.maximum(h, zero)
        return torch.einsum("bsf,fd->bsd", h, w2)

    x = A_x
    xn = _layernorm(x, axis=-1)
    s = _A_ref(xn, A_k_cache, A_v_cache, A_wq, A_wo)
    g = _silu(_B_ref(xn, B_w1, B_w2))
    return x + s * g
```

```asm
; @launch grid=(256,1,1) block=(512,1,1) lds=160928
.amdgcn_target "amdgcn-amd-amdhsa--gfx950"
.text
.globl recurrent_scan__gqa_block_cached__dense_activation_relu__decode_kernel
.p2align 8
.type recurrent_scan__gqa_block_cached__dense_activation_relu__decode_kernel,@function
recurrent_scan__gqa_block_cached__dense_activation_relu__decode_kernel:
  s_cmp_ge_u32 s2, 256
  s_cbranch_scc1 L_end
  s_load_dwordx16 s[16:31], s[0:1], 0
  s_load_dwordx4 s[32:35], s[0:1], 64
  s_load_dwordx2 s[36:37], s[0:1], 80
  v_lshrrev_b32 v1, 6, v0
  s_nop 0
  v_readfirstlane_b32 s3, v1
  v_and_b32 v0, 63, v0
  s_and_b32 s4, s2, 7
  s_lshr_b32 s5, s2, 3
  s_lshr_b32 s6, s5, 2
  s_and_b32 s7, s5, 3
  s_lshl_b32 s8, s6, 3
  s_add_u32 s8, s8, s4
  s_lshl_b32 s9, s8, 2
  s_add_u32 s9, s9, s7
  s_cmp_ge_u32 s3, 4
  s_cbranch_scc1 L_helper
  v_lshrrev_b32 v3, 4, v0
  v_bfe_u32 v4, v0, 2, 2
  v_and_b32 v5, 3, v0
  v_lshlrev_b32 v1, 9, v4
  v_lshl_add_u32 v1, v3, 6, v1
  v_lshl_add_u32 v1, v5, 4, v1
  v_and_b32 v5, 15, v0
  v_lshlrev_b32 v2, 9, v3
  v_lshl_add_u32 v2, v5, 4, v2
  s_lshl_b32 s10, s9, 19
  s_lshl_b32 s11, s3, 11
  s_mov_b32 s12, s11
  s_mul_i32 s14, s3, 28672
  s_waitcnt lgkmcnt(0)
  s_add_u32 s40, s18, s10
  s_addc_u32 s41, s19, 0
  s_and_b32 s41, s41, 0xffff
  s_mov_b32 s42, 524288
  s_mov_b32 s43, 0x20000
  s_add_u32 s44, s20, s10
  s_addc_u32 s45, s21, 0
  s_and_b32 s45, s45, 0xffff
  s_mov_b32 s46, 524288
  s_mov_b32 s47, 0x20000
  s_load_dwordx2 s[38:39], s[36:37], 0
  s_mov_b32 s54, 6291200
  s_load_dwordx2 s[52:53], s[36:37], s54
  buffer_load_dwordx4 v[56:59], v1, s[40:43], s11 offen offset:0 nt
  buffer_load_dwordx4 v[60:63], v1, s[40:43], s11 offen offset:256 nt
  s_add_u32 s11, s11, 8192
  buffer_load_dwordx4 v[64:67], v1, s[40:43], s11 offen offset:0 nt
  buffer_load_dwordx4 v[68:71], v1, s[40:43], s11 offen offset:256 nt
  s_add_u32 s11, s11, 8192
  buffer_load_dwordx4 v[72:75], v1, s[40:43], s11 offen offset:0 nt
  buffer_load_dwordx4 v[76:79], v1, s[40:43], s11 offen offset:256 nt
  s_add_u32 s11, s11, 8192
  buffer_load_dwordx4 v[80:83], v1, s[40:43], s11 offen offset:0 nt
  buffer_load_dwordx4 v[84:87], v1, s[40:43], s11 offen offset:256 nt
  s_add_u32 s11, s11, 8192
  s_mov_b64 exec, 1
  buffer_load_dword v35, v2, s[44:47], s12 offen nt
  s_mov_b64 exec, -1
  s_mov_b32 s48, s36
  s_and_b32 s49, s37, 0xffff
  s_mov_b32 s50, 6291456
  s_mov_b32 s51, 0x20000
  s_mov_b32 s60, 16843009
  s_mov_b32 s61, 16843009
  s_mov_b32 s62, 33686018
  s_mov_b32 s63, 33686018
  s_mov_b32 s64, 67372036
  s_mov_b32 s65, 67372036
  s_mov_b32 s66, 134744072
  s_mov_b32 s67, 134744072
  s_mov_b32 s68, 269488144
  s_mov_b32 s69, 269488144
  s_mov_b32 s70, 538976288
  s_mov_b32 s71, 538976288
  s_mov_b32 s72, 1077952576
  s_mov_b32 s73, 1077952576
  s_mov_b32 s74, 2155905152
  s_mov_b32 s75, 2155905152
  v_and_b32 v32, 1, v0
  v_cmp_eq_u32 vcc, 1, v32
  v_mov_b32 v33, 0xffff
  v_mov_b32 v34, 0xffff0000
  v_cndmask_b32 v33, v33, v34, vcc
  v_bfe_u32 v32, v0, 1, 2
  v_cmp_eq_u32 vcc, 0, v32
  s_nop 1
  v_cndmask_b32 v4, 0, v33, vcc
  v_cmp_eq_u32 vcc, 1, v32
  s_nop 1
  v_cndmask_b32 v5, 0, v33, vcc
  v_cmp_eq_u32 vcc, 2, v32
  s_nop 1
  v_cndmask_b32 v6, 0, v33, vcc
  v_cmp_eq_u32 vcc, 3, v32
  s_nop 1
  v_cndmask_b32 v7, 0, v33, vcc
  v_bfe_u32 v32, v0, 3, 1
  v_lshlrev_b32 v36, 9, v32
  v_lshl_add_u32 v36, v3, 6, v36
  v_and_b32 v32, 3, v0
  v_lshl_add_u32 v36, v32, 4, v36
  v_add_u32 v36, 159744, v36
  v_mov_b32 v37, 160864
  v_lshlrev_b32 v3, 4, v0
  v_add_u32 v3, s14, v3
  s_waitcnt lgkmcnt(0)
  s_lshl_b32 s56, s52, 1
  s_sub_u32 s56, s56, s38
  s_add_u32 s56, s56, 1
  s_lshl_b32 s58, s53, 1
  s_sub_u32 s58, s58, s39
  s_add_u32 s58, s58, 1
  s_and_b32 s57, s58, 0xff
  s_mov_b32 s59, 0xffffff00
  s_barrier
  s_waitcnt vmcnt(8)
  buffer_load_dwordx4 v[88:91], v1, s[40:43], s11 offen offset:0 nt
  s_waitcnt vmcnt(8)
  buffer_load_dwordx4 v[92:95], v1, s[40:43], s11 offen offset:256 nt
  s_add_u32 s11, s11, 8192
  s_waitcnt vmcnt(8)
  buffer_load_dwordx4 v[96:99], v1, s[40:43], s11 offen offset:0 nt
  s_waitcnt vmcnt(8)
  buffer_load_dwordx4 v[100:103], v1, s[40:43], s11 offen offset:256 nt
  s_add_u32 s11, s11, 8192
  s_waitcnt vmcnt(8)
  buffer_load_dwordx4 v[104:107], v1, s[40:43], s11 offen offset:0 nt
  s_waitcnt vmcnt(8)
  buffer_load_dwordx4 v[108:111], v1, s[40:43], s11 offen offset:256 nt
  s_add_u32 s11, s11, 8192
  s_waitcnt vmcnt(8)
  buffer_load_dwordx4 v[112:115], v1, s[40:43], s11 offen offset:0 nt
  s_waitcnt vmcnt(8)
  buffer_load_dwordx4 v[116:119], v1, s[40:43], s11 offen offset:256 nt
  s_add_u32 s11, s11, 8192
  s_waitcnt vmcnt(7)
  buffer_load_dwordx4 v[120:123], v1, s[40:43], s11 offen offset:0 nt
  s_waitcnt vmcnt(7)
  buffer_load_dwordx4 v[124:127], v1, s[40:43], s11 offen offset:256 nt
  s_add_u32 s11, s11, 8192
  s_waitcnt vmcnt(7)
  buffer_load_dwordx4 v[128:131], v1, s[40:43], s11 offen offset:0 nt
  s_waitcnt vmcnt(7)
  buffer_load_dwordx4 v[132:135], v1, s[40:43], s11 offen offset:256 nt
  s_add_u32 s11, s11, 8192
  s_waitcnt vmcnt(7)
  buffer_load_dwordx4 v[136:139], v1, s[40:43], s11 offen offset:0 nt
  s_waitcnt vmcnt(7)
  buffer_load_dwordx4 v[140:143], v1, s[40:43], s11 offen offset:256 nt
  s_add_u32 s11, s11, 8192
  s_waitcnt vmcnt(7)
  buffer_load_dwordx4 v[144:147], v1, s[40:43], s11 offen offset:0 nt
  s_waitcnt vmcnt(7)
  buffer_load_dwordx4 v[148:151], v1, s[40:43], s11 offen offset:256 nt
  s_add_u32 s11, s11, 8192
  s_waitcnt vmcnt(7)
  buffer_load_dwordx4 v[152:155], v1, s[40:43], s11 offen offset:0 nt
  s_waitcnt vmcnt(7)
  buffer_load_dwordx4 v[156:159], v1, s[40:43], s11 offen offset:256 nt
  s_add_u32 s11, s11, 8192
  s_waitcnt vmcnt(7)
  buffer_load_dwordx4 v[160:163], v1, s[40:43], s11 offen offset:0 nt
  s_waitcnt vmcnt(7)
  buffer_load_dwordx4 v[164:167], v1, s[40:43], s11 offen offset:256 nt
  s_add_u32 s11, s11, 8192
  s_waitcnt vmcnt(7)
  buffer_load_dwordx4 v[168:171], v1, s[40:43], s11 offen offset:0 nt
  s_waitcnt vmcnt(7)
  buffer_load_dwordx4 v[172:175], v1, s[40:43], s11 offen offset:256 nt
  s_add_u32 s11, s11, 8192
  s_waitcnt vmcnt(7)
  buffer_load_dwordx4 v[176:179], v1, s[40:43], s11 offen offset:0 nt
  s_waitcnt vmcnt(7)
  buffer_load_dwordx4 v[180:183], v1, s[40:43], s11 offen offset:256 nt
  s_add_u32 s11, s11, 8192
  s_waitcnt vmcnt(7)
  buffer_load_dwordx4 v[184:187], v1, s[40:43], s11 offen offset:0 nt
  s_waitcnt vmcnt(7)
  buffer_load_dwordx4 v[188:191], v1, s[40:43], s11 offen offset:256 nt
  s_add_u32 s11, s11, 8192
  s_waitcnt vmcnt(7)
  buffer_load_dwordx4 v[192:195], v1, s[40:43], s11 offen offset:0 nt
  s_waitcnt vmcnt(7)
  buffer_load_dwordx4 v[196:199], v1, s[40:43], s11 offen offset:256 nt
  s_add_u32 s11, s11, 8192
  s_waitcnt vmcnt(7)
  buffer_load_dwordx4 v[200:203], v1, s[40:43], s11 offen offset:0 nt
  s_waitcnt vmcnt(7)
  buffer_load_dwordx4 v[204:207], v1, s[40:43], s11 offen offset:256 nt
  s_add_u32 s11, s11, 8192
  s_waitcnt vmcnt(7)
  buffer_load_dwordx4 v[208:211], v1, s[40:43], s11 offen offset:0 nt
  s_waitcnt vmcnt(7)
  buffer_load_dwordx4 v[212:215], v1, s[40:43], s11 offen offset:256 nt
  s_add_u32 s11, s11, 8192
  s_waitcnt vmcnt(7)
  buffer_load_dwordx4 v[216:219], v1, s[40:43], s11 offen offset:0 nt
  s_waitcnt vmcnt(7)
  buffer_load_dwordx4 v[220:223], v1, s[40:43], s11 offen offset:256 nt
  s_add_u32 s11, s11, 8192
  s_waitcnt vmcnt(7)
  buffer_load_dwordx4 v[224:227], v1, s[40:43], s11 offen offset:0 nt
  s_waitcnt vmcnt(7)
  buffer_load_dwordx4 v[228:231], v1, s[40:43], s11 offen offset:256 nt
  s_add_u32 s11, s11, 8192
  s_waitcnt vmcnt(7)
  buffer_load_dwordx4 v[232:235], v1, s[40:43], s11 offen offset:0 nt
  s_waitcnt vmcnt(7)
  buffer_load_dwordx4 v[236:239], v1, s[40:43], s11 offen offset:256 nt
  s_add_u32 s11, s11, 8192
  s_waitcnt vmcnt(7)
  buffer_load_dwordx4 v[240:243], v1, s[40:43], s11 offen offset:0 nt
  s_waitcnt vmcnt(7)
  buffer_load_dwordx4 v[244:247], v1, s[40:43], s11 offen offset:256 nt
  s_add_u32 s11, s11, 8192
  s_waitcnt vmcnt(7)
  buffer_load_dwordx4 v[248:251], v1, s[40:43], s11 offen offset:0 nt
  s_waitcnt vmcnt(7)
  buffer_load_dwordx4 v[252:255], v1, s[40:43], s11 offen offset:256 nt
  s_add_u32 s11, s11, 8192
  s_waitcnt vmcnt(7)
  s_add_u32 m0, s14, 0
  s_nop 0
  buffer_load_dwordx4 v1, s[40:43], s11 offen offset:0 nt lds
  s_waitcnt vmcnt(7)
  s_add_u32 m0, s14, 768
  s_nop 0
  buffer_load_dwordx4 v1, s[40:43], s11 offen offset:256 nt lds
  s_add_u32 s11, s11, 8192
  s_waitcnt vmcnt(7)
  s_add_u32 m0, s14, 2048
  s_nop 0
  buffer_load_dwordx4 v1, s[40:43], s11 offen offset:0 nt lds
  s_waitcnt vmcnt(7)
  s_add_u32 m0, s14, 2816
  s_nop 0
  buffer_load_dwordx4 v1, s[40:43], s11 offen offset:256 nt lds
  s_add_u32 s11, s11, 8192
  s_waitcnt vmcnt(7)
  s_add_u32 m0, s14, 4096
  s_nop 0
  buffer_load_dwordx4 v1, s[40:43], s11 offen offset:0 nt lds
  s_waitcnt vmcnt(7)
  s_add_u32 m0, s14, 4864
  s_nop 0
  buffer_load_dwordx4 v1, s[40:43], s11 offen offset:256 nt lds
  s_add_u32 s11, s11, 8192
  s_waitcnt vmcnt(7)
  s_add_u32 m0, s14, 6144
  s_nop 0
  buffer_load_dwordx4 v1, s[40:43], s11 offen offset:0 nt lds
  s_waitcnt vmcnt(7)
  s_add_u32 m0, s14, 6912
  s_nop 0
  buffer_load_dwordx4 v1, s[40:43], s11 offen offset:256 nt lds
  s_add_u32 s11, s11, 8192
  s_waitcnt vmcnt(7)
  s_add_u32 m0, s14, 8192
  s_nop 0
  buffer_load_dwordx4 v1, s[40:43], s11 offen offset:0 nt lds
  s_waitcnt vmcnt(7)
  s_add_u32 m0, s14, 8960
  s_nop 0
  buffer_load_dwordx4 v1, s[40:43], s11 offen offset:256 nt lds
  s_add_u32 s11, s11, 8192
  s_waitcnt vmcnt(7)
  s_add_u32 m0, s14, 10240
  s_nop 0
  buffer_load_dwordx4 v1, s[40:43], s11 offen offset:0 nt lds
  s_waitcnt vmcnt(7)
  s_add_u32 m0, s14, 11008
  s_nop 0
  buffer_load_dwordx4 v1, s[40:43], s11 offen offset:256 nt lds
  s_add_u32 s11, s11, 8192
  s_waitcnt vmcnt(7)
  s_add_u32 m0, s14, 12288
  s_nop 0
  buffer_load_dwordx4 v1, s[40:43], s11 offen offset:0 nt lds
  s_waitcnt vmcnt(7)
  s_add_u32 m0, s14, 13056
  s_nop 0
  buffer_load_dwordx4 v1, s[40:43], s11 offen offset:256 nt lds
  s_add_u32 s11, s11, 8192
  s_waitcnt vmcnt(7)
  s_add_u32 m0, s14, 14336
  s_nop 0
  buffer_load_dwordx4 v1, s[40:43], s11 offen offset:0 nt lds
  s_waitcnt vmcnt(7)
  s_add_u32 m0, s14, 15104
  s_nop 0
  buffer_load_dwordx4 v1, s[40:43], s11 offen offset:256 nt lds
  s_add_u32 s11, s11, 8192
  s_waitcnt vmcnt(7)
  s_add_u32 m0, s14, 16384
  s_nop 0
  buffer_load_dwordx4 v1, s[40:43], s11 offen offset:0 nt lds
  s_waitcnt vmcnt(7)
  s_add_u32 m0, s14, 17152
  s_nop 0
  buffer_load_dwordx4 v1, s[40:43], s11 offen offset:256 nt lds
  s_add_u32 s11, s11, 8192
  s_waitcnt vmcnt(7)
  s_add_u32 m0, s14, 18432
  s_nop 0
  buffer_load_dwordx4 v1, s[40:43], s11 offen offset:0 nt lds
  s_waitcnt vmcnt(7)
  s_add_u32 m0, s14, 19200
  s_nop 0
  buffer_load_dwordx4 v1, s[40:43], s11 offen offset:256 nt lds
  s_add_u32 s11, s11, 8192
  s_waitcnt vmcnt(7)
  s_add_u32 m0, s14, 20480
  s_nop 0
  buffer_load_dwordx4 v1, s[40:43], s11 offen offset:0 nt lds
  s_waitcnt vmcnt(7)
  s_add_u32 m0, s14, 21248
  s_nop 0
  buffer_load_dwordx4 v1, s[40:43], s11 offen offset:256 nt lds
  s_add_u32 s11, s11, 8192
  s_waitcnt vmcnt(7)
  s_add_u32 m0, s14, 22528
  s_nop 0
  buffer_load_dwordx4 v1, s[40:43], s11 offen offset:0 nt lds
  s_waitcnt vmcnt(7)
  s_add_u32 m0, s14, 23296
  s_nop 0
  buffer_load_dwordx4 v1, s[40:43], s11 offen offset:256 nt lds
  s_add_u32 s11, s11, 8192
  s_waitcnt vmcnt(7)
  s_add_u32 m0, s14, 24576
  s_nop 0
  buffer_load_dwordx4 v1, s[40:43], s11 offen offset:0 nt lds
  s_waitcnt vmcnt(7)
  s_add_u32 m0, s14, 25344
  s_nop 0
  buffer_load_dwordx4 v1, s[40:43], s11 offen offset:256 nt lds
  s_add_u32 s11, s11, 8192
  s_waitcnt vmcnt(7)
  s_add_u32 m0, s14, 26624
  s_nop 0
  buffer_load_dwordx4 v1, s[40:43], s11 offen offset:0 nt lds
  s_waitcnt vmcnt(7)
  s_add_u32 m0, s14, 27392
  s_nop 0
  buffer_load_dwordx4 v1, s[40:43], s11 offen offset:256 nt lds
  s_add_u32 s11, s11, 8192
L_qwait_1:
  ds_read_b32 v32, v37 offset:0
  s_waitcnt lgkmcnt(0)
  v_readfirstlane_b32 s13, v32
  s_nop 1
  s_cmp_lg_u32 s13, 0
  s_nop 1
  s_cbranch_scc1 L_qwait_ok_2
  s_sleep 1
  s_branch L_qwait_1
L_qwait_ok_2:
  ds_read_b128 v[8:11], v36
  ds_read_b128 v[12:15], v36 offset:256
  s_waitcnt lgkmcnt(0)
  v_mfma_f32_16x16x32_bf16 v[16:19], v[56:59], v[8:11], 0
  v_mfma_f32_16x16x32_bf16 v[16:19], v[60:63], v[12:15], v[16:19]
  v_mfma_f32_16x16x32_bf16 v[20:23], v[64:67], v[8:11], 0
  v_mfma_f32_16x16x32_bf16 v[20:23], v[68:71], v[12:15], v[20:23]
  s_nop 5
  v_mov_b32_dpp v32, v16 quad_perm:[0,0,0,0] row_mask:0xf bank_mask:0xf
  v_add_f32_dpp v32, v17, v32 quad_perm:[1,1,1,1] row_mask:0xf bank_mask:0xf
  v_add_f32_dpp v32, v18, v32 quad_perm:[2,2,2,2] row_mask:0xf bank_mask:0xf
  v_add_f32_dpp v32, v19, v32 quad_perm:[3,3,3,3] row_mask:0xf bank_mask:0xf
  v_mov_b32 v24, v32
  s_waitcnt vmcnt(7)
  buffer_load_dwordx4 v[56:59], v1, s[40:43], s11 offen offset:0 nt
  s_waitcnt vmcnt(7)
  buffer_load_dwordx4 v[60:63], v1, s[40:43], s11 offen offset:256 nt
  s_add_u32 s11, s11, 8192
  v_mfma_f32_16x16x32_bf16 v[16:19], v[72:75], v[8:11], 0
  v_mfma_f32_16x16x32_bf16 v[16:19], v[76:79], v[12:15], v[16:19]
  v_mov_b32_dpp v32, v20 quad_perm:[0,0,0,0] row_mask:0xf bank_mask:0xf
  v_add_f32_dpp v32, v21, v32 quad_perm:[1,1,1,1] row_mask:0xf bank_mask:0xf
  v_add_f32_dpp v32, v22, v32 quad_perm:[2,2,2,2] row_mask:0xf bank_mask:0xf
  v_add_f32_dpp v32, v23, v32 quad_perm:[3,3,3,3] row_mask:0xf bank_mask:0xf
  v_cndmask_b32 v24, v24, v32, s[62:63]
  v_mfma_f32_16x16x32_bf16 v[20:23], v[80:83], v[8:11], 0
  v_mfma_f32_16x16x32_bf16 v[20:23], v[84:87], v[12:15], v[20:23]
  s_nop 0
  v_mov_b32_dpp v32, v16 quad_perm:[0,0,0,0] row_mask:0xf bank_mask:0xf
  v_add_f32_dpp v32, v17, v32 quad_perm:[1,1,1,1] row_mask:0xf bank_mask:0xf
  v_add_f32_dpp v32, v18, v32 quad_perm:[2,2,2,2] row_mask:0xf bank_mask:0xf
  v_add_f32_dpp v32, v19, v32 quad_perm:[3,3,3,3] row_mask:0xf bank_mask:0xf
  v_cndmask_b32 v24, v24, v32, s[64:65]
  s_waitcnt vmcnt(7)
  buffer_load_dwordx4 v[64:67], v1, s[40:43], s11 offen offset:0 nt
  s_waitcnt vmcnt(7)
  buffer_load_dwordx4 v[68:71], v1, s[40:43], s11 offen offset:256 nt
  s_add_u32 s11, s11, 8192
  v_mfma_f32_16x16x32_bf16 v[16:19], v[88:91], v[8:11], 0
  v_mfma_f32_16x16x32_bf16 v[16:19], v[92:95], v[12:15], v[16:19]
  v_mov_b32_dpp v32, v20 quad_perm:[0,0,0,0] row_mask:0xf bank_mask:0xf
  v_add_f32_dpp v32, v21, v32 quad_perm:[1,1,1,1] row_mask:0xf bank_mask:0xf
  v_add_f32_dpp v32, v22, v32 quad_perm:[2,2,2,2] row_mask:0xf bank_mask:0xf
  v_add_f32_dpp v32, v23, v32 quad_perm:[3,3,3,3] row_mask:0xf bank_mask:0xf
  v_cndmask_b32 v24, v24, v32, s[66:67]
  v_mfma_f32_16x16x32_bf16 v[20:23], v[96:99], v[8:11], 0
  v_mfma_f32_16x16x32_bf16 v[20:23], v[100:103], v[12:15], v[20:23]
  s_nop 0
  v_mov_b32_dpp v32, v16 quad_perm:[0,0,0,0] row_mask:0xf bank_mask:0xf
  v_add_f32_dpp v32, v17, v32 quad_perm:[1,1,1,1] row_mask:0xf bank_mask:0xf
  v_add_f32_dpp v32, v18, v32 quad_perm:[2,2,2,2] row_mask:0xf bank_mask:0xf
  v_add_f32_dpp v32, v19, v32 quad_perm:[3,3,3,3] row_mask:0xf bank_mask:0xf
  v_cndmask_b32 v24, v24, v32, s[68:69]
  s_waitcnt vmcnt(7)
  buffer_load_dwordx4 v[72:75], v1, s[40:43], s11 offen offset:0 nt
  s_waitcnt vmcnt(7)
  buffer_load_dwordx4 v[76:79], v1, s[40:43], s11 offen offset:256 nt
  s_add_u32 s11, s11, 8192
  v_mfma_f32_16x16x32_bf16 v[16:19], v[104:107], v[8:11], 0
  v_mfma_f32_16x16x32_bf16 v[16:19], v[108:111], v[12:15], v[16:19]
  v_mov_b32_dpp v32, v20 quad_perm:[0,0,0,0] row_mask:0xf bank_mask:0xf
  v_add_f32_dpp v32, v21, v32 quad_perm:[1,1,1,1] row_mask:0xf bank_mask:0xf
  v_add_f32_dpp v32, v22, v32 quad_perm:[2,2,2,2] row_mask:0xf bank_mask:0xf
  v_add_f32_dpp v32, v23, v32 quad_perm:[3,3,3,3] row_mask:0xf bank_mask:0xf
  v_cndmask_b32 v24, v24, v32, s[70:71]
  v_mfma_f32_16x16x32_bf16 v[20:23], v[112:115], v[8:11], 0
  v_mfma_f32_16x16x32_bf16 v[20:23], v[116:119], v[12:15], v[20:23]
  s_nop 0
  v_mov_b32_dpp v32, v16 quad_perm:[0,0,0,0] row_mask:0xf bank_mask:0xf
  v_add_f32_dpp v32, v17, v32 quad_perm:[1,1,1,1] row_mask:0xf bank_mask:0xf
  v_add_f32_dpp v32, v18, v32 quad_perm:[2,2,2,2] row_mask:0xf bank_mask:0xf
  v_add_f32_dpp v32, v19, v32 quad_perm:[3,3,3,3] row_mask:0xf bank_mask:0xf
  v_cndmask_b32 v24, v24, v32, s[72:73]
  s_waitcnt vmcnt(7)
  buffer_load_dwordx4 v[80:83], v1, s[40:43], s11 offen offset:0 nt
  s_waitcnt vmcnt(7)
  buffer_load_dwordx4 v[84:87], v1, s[40:43], s11 offen offset:256 nt
  s_add_u32 s11, s11, 8192
  v_mfma_f32_16x16x32_bf16 v[16:19], v[120:123], v[8:11], 0
  v_mfma_f32_16x16x32_bf16 v[16:19], v[124:127], v[12:15], v[16:19]
  v_mov_b32_dpp v32, v20 quad_perm:[0,0,0,0] row_mask:0xf bank_mask:0xf
  v_add_f32_dpp v32, v21, v32 quad_perm:[1,1,1,1] row_mask:0xf bank_mask:0xf
  v_add_f32_dpp v32, v22, v32 quad_perm:[2,2,2,2] row_mask:0xf bank_mask:0xf
  v_add_f32_dpp v32, v23, v32 quad_perm:[3,3,3,3] row_mask:0xf bank_mask:0xf
  v_cndmask_b32 v24, v24, v32, s[74:75]
  v_mfma_f32_16x16x32_bf16 v[20:23], v[128:131], v[8:11], 0
  v_mfma_f32_16x16x32_bf16 v[20:23], v[132:135], v[12:15], v[20:23]
  s_nop 0
  v_mov_b32_dpp v32, v16 quad_perm:[0,0,0,0] row_mask:0xf bank_mask:0xf
  v_add_f32_dpp v32, v17, v32 quad_perm:[1,1,1,1] row_mask:0xf bank_mask:0xf
  v_add_f32_dpp v32, v18, v32 quad_perm:[2,2,2,2] row_mask:0xf bank_mask:0xf
  v_add_f32_dpp v32, v19, v32 quad_perm:[3,3,3,3] row_mask:0xf bank_mask:0xf
  v_mov_b32 v25, v32
  s_waitcnt vmcnt(7)
  buffer_load_dwordx4 v[88:91], v1, s[40:43], s11 offen offset:0 nt
  s_waitcnt vmcnt(7)
  buffer_load_dwordx4 v[92:95], v1, s[40:43], s11 offen offset:256 nt
  s_add_u32 s11, s11, 8192
  v_mfma_f32_16x16x32_bf16 v[16:19], v[136:139], v[8:11], 0
  v_mfma_f32_16x16x32_bf16 v[16:19], v[140:143], v[12:15], v[16:19]
  v_mov_b32_dpp v32, v20 quad_perm:[0,0,0,0] row_mask:0xf bank_mask:0xf
  v_add_f32_dpp v32, v21, v32 quad_perm:[1,1,1,1] row_mask:0xf bank_mask:0xf
  v_add_f32_dpp v32, v22, v32 quad_perm:[2,2,2,2] row_mask:0xf bank_mask:0xf
  v_add_f32_dpp v32, v23, v32 quad_perm:[3,3,3,3] row_mask:0xf bank_mask:0xf
  v_cndmask_b32 v25, v25, v32, s[62:63]
  v_mfma_f32_16x16x32_bf16 v[20:23], v[144:147], v[8:11], 0
  v_mfma_f32_16x16x32_bf16 v[20:23], v[148:151], v[12:15], v[20:23]
  s_nop 0
  v_mov_b32_dpp v32, v16 quad_perm:[0,0,0,0] row_mask:0xf bank_mask:0xf
  v_add_f32_dpp v32, v17, v32 quad_perm:[1,1,1,1] row_mask:0xf bank_mask:0xf
  v_add_f32_dpp v32, v18, v32 quad_perm:[2,2,2,2] row_mask:0xf bank_mask:0xf
  v_add_f32_dpp v32, v19, v32 quad_perm:[3,3,3,3] row_mask:0xf bank_mask:0xf
  v_cndmask_b32 v25, v25, v32, s[64:65]
  s_waitcnt vmcnt(7)
  buffer_load_dwordx4 v[96:99], v1, s[40:43], s11 offen offset:0 nt
  s_waitcnt vmcnt(7)
  buffer_load_dwordx4 v[100:103], v1, s[40:43], s11 offen offset:256 nt
  s_add_u32 s11, s11, 8192
  v_mfma_f32_16x16x32_bf16 v[16:19], v[152:155], v[8:11], 0
  v_mfma_f32_16x16x32_bf16 v[16:19], v[156:159], v[12:15], v[16:19]
  v_mov_b32_dpp v32, v20 quad_perm:[0,0,0,0] row_mask:0xf bank_mask:0xf
  v_add_f32_dpp v32, v21, v32 quad_perm:[1,1,1,1] row_mask:0xf bank_mask:0xf
  v_add_f32_dpp v32, v22, v32 quad_perm:[2,2,2,2] row_mask:0xf bank_mask:0xf
  v_add_f32_dpp v32, v23, v32 quad_perm:[3,3,3,3] row_mask:0xf bank_mask:0xf
  v_cndmask_b32 v25, v25, v32, s[66:67]
  v_mfma_f32_16x16x32_bf16 v[20:23], v[160:163], v[8:11], 0
  v_mfma_f32_16x16x32_bf16 v[20:23], v[164:167], v[12:15], v[20:23]
  s_nop 0
  v_mov_b32_dpp v32, v16 quad_perm:[0,0,0,0] row_mask:0xf bank_mask:0xf
  v_add_f32_dpp v32, v17, v32 quad_perm:[1,1,1,1] row_mask:0xf bank_mask:0xf
  v_add_f32_dpp v32, v18, v32 quad_perm:[2,2,2,2] row_mask:0xf bank_mask:0xf
  v_add_f32_dpp v32, v19, v32 quad_perm:[3,3,3,3] row_mask:0xf bank_mask:0xf
  v_cndmask_b32 v25, v25, v32, s[68:69]
  s_waitcnt vmcnt(7)
  buffer_load_dwordx4 v[104:107], v1, s[40:43], s11 offen offset:0 nt
  s_waitcnt vmcnt(7)
  buffer_load_dwordx4 v[108:111], v1, s[40:43], s11 offen offset:256 nt
  s_add_u32 s11, s11, 8192
  v_mfma_f32_16x16x32_bf16 v[16:19], v[168:171], v[8:11], 0
  v_mfma_f32_16x16x32_bf16 v[16:19], v[172:175], v[12:15], v[16:19]
  v_mov_b32_dpp v32, v20 quad_perm:[0,0,0,0] row_mask:0xf bank_mask:0xf
  v_add_f32_dpp v32, v21, v32 quad_perm:[1,1,1,1] row_mask:0xf bank_mask:0xf
  v_add_f32_dpp v32, v22, v32 quad_perm:[2,2,2,2] row_mask:0xf bank_mask:0xf
  v_add_f32_dpp v32, v23, v32 quad_perm:[3,3,3,3] row_mask:0xf bank_mask:0xf
  v_cndmask_b32 v25, v25, v32, s[70:71]
  v_mfma_f32_16x16x32_bf16 v[20:23], v[176:179], v[8:11], 0
  v_mfma_f32_16x16x32_bf16 v[20:23], v[180:183], v[12:15], v[20:23]
  s_nop 0
  v_mov_b32_dpp v32, v16 quad_perm:[0,0,0,0] row_mask:0xf bank_mask:0xf
  v_add_f32_dpp v32, v17, v32 quad_perm:[1,1,1,1] row_mask:0xf bank_mask:0xf
  v_add_f32_dpp v32, v18, v32 quad_perm:[2,2,2,2] row_mask:0xf bank_mask:0xf
  v_add_f32_dpp v32, v19, v32 quad_perm:[3,3,3,3] row_mask:0xf bank_mask:0xf
  v_cndmask_b32 v25, v25, v32, s[72:73]
  s_waitcnt vmcnt(7)
  buffer_load_dwordx4 v[112:115], v1, s[40:43], s11 offen offset:0 nt
  s_waitcnt vmcnt(7)
  buffer_load_dwordx4 v[116:119], v1, s[40:43], s11 offen offset:256 nt
  s_add_u32 s11, s11, 8192
  v_mfma_f32_16x16x32_bf16 v[16:19], v[184:187], v[8:11], 0
  v_mfma_f32_16x16x32_bf16 v[16:19], v[188:191], v[12:15], v[16:19]
  v_mov_b32_dpp v32, v20 quad_perm:[0,0,0,0] row_mask:0xf bank_mask:0xf
  v_add_f32_dpp v32, v21, v32 quad_perm:[1,1,1,1] row_mask:0xf bank_mask:0xf
  v_add_f32_dpp v32, v22, v32 quad_perm:[2,2,2,2] row_mask:0xf bank_mask:0xf
  v_add_f32_dpp v32, v23, v32 quad_perm:[3,3,3,3] row_mask:0xf bank_mask:0xf
  v_cndmask_b32 v25, v25, v32, s[74:75]
  v_mfma_f32_16x16x32_bf16 v[20:23], v[192:195], v[8:11], 0
  v_mfma_f32_16x16x32_bf16 v[20:23], v[196:199], v[12:15], v[20:23]
  s_nop 0
  v_mov_b32_dpp v32, v16 quad_perm:[0,0,0,0] row_mask:0xf bank_mask:0xf
  v_add_f32_dpp v32, v17, v32 quad_perm:[1,1,1,1] row_mask:0xf bank_mask:0xf
  v_add_f32_dpp v32, v18, v32 quad_perm:[2,2,2,2] row_mask:0xf bank_mask:0xf
  v_add_f32_dpp v32, v19, v32 quad_perm:[3,3,3,3] row_mask:0xf bank_mask:0xf
  v_mov_b32 v26, v32
  s_waitcnt vmcnt(7)
  buffer_load_dwordx4 v[120:123], v1, s[40:43], s11 offen offset:0 nt
  s_waitcnt vmcnt(7)
  buffer_load_dwordx4 v[124:127], v1, s[40:43], s11 offen offset:256 nt
  s_add_u32 s11, s11, 8192
  v_mfma_f32_16x16x32_bf16 v[16:19], v[200:203], v[8:11], 0
  v_mfma_f32_16x16x32_bf16 v[16:19], v[204:207], v[12:15], v[16:19]
  v_mov_b32_dpp v32, v20 quad_perm:[0,0,0,0] row_mask:0xf bank_mask:0xf
  v_add_f32_dpp v32, v21, v32 quad_perm:[1,1,1,1] row_mask:0xf bank_mask:0xf
  v_add_f32_dpp v32, v22, v32 quad_perm:[2,2,2,2] row_mask:0xf bank_mask:0xf
  v_add_f32_dpp v32, v23, v32 quad_perm:[3,3,3,3] row_mask:0xf bank_mask:0xf
  v_cndmask_b32 v26, v26, v32, s[62:63]
  v_mfma_f32_16x16x32_bf16 v[20:23], v[208:211], v[8:11], 0
  v_mfma_f32_16x16x32_bf16 v[20:23], v[212:215], v[12:15], v[20:23]
  s_nop 0
  v_mov_b32_dpp v32, v16 quad_perm:[0,0,0,0] row_mask:0xf bank_mask:0xf
  v_add_f32_dpp v32, v17, v32 quad_perm:[1,1,1,1] row_mask:0xf bank_mask:0xf
  v_add_f32_dpp v32, v18, v32 quad_perm:[2,2,2,2] row_mask:0xf bank_mask:0xf
  v_add_f32_dpp v32, v19, v32 quad_perm:[3,3,3,3] row_mask:0xf bank_mask:0xf
  v_cndmask_b32 v26, v26, v32, s[64:65]
  s_waitcnt vmcnt(7)
  buffer_load_dwordx4 v[128:131], v1, s[40:43], s11 offen offset:0 nt
  s_waitcnt vmcnt(7)
  buffer_load_dwordx4 v[132:135], v1, s[40:43], s11 offen offset:256 nt
  s_add_u32 s11, s11, 8192
  v_mfma_f32_16x16x32_bf16 v[16:19], v[216:219], v[8:11], 0
  v_mfma_f32_16x16x32_bf16 v[16:19], v[220:223], v[12:15], v[16:19]
  v_mov_b32_dpp v32, v20 quad_perm:[0,0,0,0] row_mask:0xf bank_mask:0xf
  v_add_f32_dpp v32, v21, v32 quad_perm:[1,1,1,1] row_mask:0xf bank_mask:0xf
  v_add_f32_dpp v32, v22, v32 quad_perm:[2,2,2,2] row_mask:0xf bank_mask:0xf
  v_add_f32_dpp v32, v23, v32 quad_perm:[3,3,3,3] row_mask:0xf bank_mask:0xf
  v_cndmask_b32 v26, v26, v32, s[66:67]
  v_mfma_f32_16x16x32_bf16 v[20:23], v[224:227], v[8:11], 0
  v_mfma_f32_16x16x32_bf16 v[20:23], v[228:231], v[12:15], v[20:23]
  s_nop 0
  v_mov_b32_dpp v32, v16 quad_perm:[0,0,0,0] row_mask:0xf bank_mask:0xf
  v_add_f32_dpp v32, v17, v32 quad_perm:[1,1,1,1] row_mask:0xf bank_mask:0xf
  v_add_f32_dpp v32, v18, v32 quad_perm:[2,2,2,2] row_mask:0xf bank_mask:0xf
  v_add_f32_dpp v32, v19, v32 quad_perm:[3,3,3,3] row_mask:0xf bank_mask:0xf
  v_cndmask_b32 v26, v26, v32, s[68:69]
  s_waitcnt vmcnt(7)
  buffer_load_dwordx4 v[136:139], v1, s[40:43], s11 offen offset:0 nt
  s_waitcnt vmcnt(7)
  buffer_load_dwordx4 v[140:143], v1, s[40:43], s11 offen offset:256 nt
  s_add_u32 s11, s11, 8192
  v_mfma_f32_16x16x32_bf16 v[16:19], v[232:235], v[8:11], 0
  v_mfma_f32_16x16x32_bf16 v[16:19], v[236:239], v[12:15], v[16:19]
  v_mov_b32_dpp v32, v20 quad_perm:[0,0,0,0] row_mask:0xf bank_mask:0xf
  v_add_f32_dpp v32, v21, v32 quad_perm:[1,1,1,1] row_mask:0xf bank_mask:0xf
  v_add_f32_dpp v32, v22, v32 quad_perm:[2,2,2,2] row_mask:0xf bank_mask:0xf
  v_add_f32_dpp v32, v23, v32 quad_perm:[3,3,3,3] row_mask:0xf bank_mask:0xf
  v_cndmask_b32 v26, v26, v32, s[70:71]
  v_mfma_f32_16x16x32_bf16 v[20:23], v[240:243], v[8:11], 0
  v_mfma_f32_16x16x32_bf16 v[20:23], v[244:247], v[12:15], v[20:23]
  s_nop 0
  v_mov_b32_dpp v32, v16 quad_perm:[0,0,0,0] row_mask:0xf bank_mask:0xf
  v_add_f32_dpp v32, v17, v32 quad_perm:[1,1,1,1] row_mask:0xf bank_mask:0xf
  v_add_f32_dpp v32, v18, v32 quad_perm:[2,2,2,2] row_mask:0xf bank_mask:0xf
  v_add_f32_dpp v32, v19, v32 quad_perm:[3,3,3,3] row_mask:0xf bank_mask:0xf
  v_cndmask_b32 v26, v26, v32, s[72:73]
  s_waitcnt vmcnt(7)
  buffer_load_dwordx4 v[144:147], v1, s[40:43], s11 offen offset:0 nt
  s_waitcnt vmcnt(7)
  buffer_load_dwordx4 v[148:151], v1, s[40:43], s11 offen offset:256 nt
  s_add_u32 s11, s11, 8192
  ds_read_b128 v[48:51], v3 offset:0
  ds_read_b128 v[52:55], v3 offset:1024
  v_mfma_f32_16x16x32_bf16 v[16:19], v[248:251], v[8:11], 0
  v_mfma_f32_16x16x32_bf16 v[16:19], v[252:255], v[12:15], v[16:19]
  v_mov_b32_dpp v32, v20 quad_perm:[0,0,0,0] row_mask:0xf bank_mask:0xf
  v_add_f32_dpp v32, v21, v32 quad_perm:[1,1,1,1] row_mask:0xf bank_mask:0xf
  v_add_f32_dpp v32, v22, v32 quad_perm:[2,2,2,2] row_mask:0xf bank_mask:0xf
  v_add_f32_dpp v32, v23, v32 quad_perm:[3,3,3,3] row_mask:0xf bank_mask:0xf
  v_cndmask_b32 v26, v26, v32, s[74:75]
  ds_read_b128 v[40:43], v3 offset:2048
  ds_read_b128 v[44:47], v3 offset:3072
  s_waitcnt lgkmcnt(2)
  v_mfma_f32_16x16x32_bf16 v[20:23], v[48:51], v[8:11], 0
  v_mfma_f32_16x16x32_bf16 v[20:23], v[52:55], v[12:15], v[20:23]
  v_mov_b32_dpp v32, v16 quad_perm:[0,0,0,0] row_mask:0xf bank_mask:0xf
  v_add_f32_dpp v32, v17, v32 quad_perm:[1,1,1,1] row_mask:0xf bank_mask:0xf
  v_add_f32_dpp v32, v18, v32 quad_perm:[2,2,2,2] row_mask:0xf bank_mask:0xf
  v_add_f32_dpp v32, v19, v32 quad_perm:[3,3,3,3] row_mask:0xf bank_mask:0xf
  v_mov_b32 v27, v32
  s_waitcnt vmcnt(7)
  buffer_load_dwordx4 v[152:155], v1, s[40:43], s11 offen offset:0 nt
  s_waitcnt vmcnt(7)
  buffer_load_dwordx4 v[156:159], v1, s[40:43], s11 offen offset:256 nt
  s_add_u32 s11, s11, 8192
  ds_read_b128 v[48:51], v3 offset:4096
  ds_read_b128 v[52:55], v3 offset:5120
  s_waitcnt lgkmcnt(2)
  v_mfma_f32_16x16x32_bf16 v[16:19], v[40:43], v[8:11], 0
  v_mfma_f32_16x16x32_bf16 v[16:19], v[44:47], v[12:15], v[16:19]
  v_mov_b32_dpp v32, v20 quad_perm:[0,0,0,0] row_mask:0xf bank_mask:0xf
  v_add_f32_dpp v32, v21, v32 quad_perm:[1,1,1,1] row_mask:0xf bank_mask:0xf
  v_add_f32_dpp v32, v22, v32 quad_perm:[2,2,2,2] row_mask:0xf bank_mask:0xf
  v_add_f32_dpp v32, v23, v32 quad_perm:[3,3,3,3] row_mask:0xf bank_mask:0xf
  v_cndmask_b32 v27, v27, v32, s[62:63]
  ds_read_b128 v[40:43], v3 offset:6144
  ds_read_b128 v[44:47], v3 offset:7168
  s_waitcnt lgkmcnt(2)
  v_mfma_f32_16x16x32_bf16 v[20:23], v[48:51], v[8:11], 0
  v_mfma_f32_16x16x32_bf16 v[20:23], v[52:55], v[12:15], v[20:23]
  v_mov_b32_dpp v32, v16 quad_perm:[0,0,0,0] row_mask:0xf bank_mask:0xf
  v_add_f32_dpp v32, v17, v32 quad_perm:[1,1,1,1] row_mask:0xf bank_mask:0xf
  v_add_f32_dpp v32, v18, v32 quad_perm:[2,2,2,2] row_mask:0xf bank_mask:0xf
  v_add_f32_dpp v32, v19, v32 quad_perm:[3,3,3,3] row_mask:0xf bank_mask:0xf
  v_cndmask_b32 v27, v27, v32, s[64:65]
  s_waitcnt vmcnt(7)
  buffer_load_dwordx4 v[160:163], v1, s[40:43], s11 offen offset:0 nt
  s_waitcnt vmcnt(7)
  buffer_load_dwordx4 v[164:167], v1, s[40:43], s11 offen offset:256 nt
  s_add_u32 s11, s11, 8192
  ds_read_b128 v[48:51], v3 offset:8192
  ds_read_b128 v[52:55], v3 offset:9216
  s_waitcnt lgkmcnt(2)
  v_mfma_f32_16x16x32_bf16 v[16:19], v[40:43], v[8:11], 0
  v_mfma_f32_16x16x32_bf16 v[16:19], v[44:47], v[12:15], v[16:19]
  v_mov_b32_dpp v32, v20 quad_perm:[0,0,0,0] row_mask:0xf bank_mask:0xf
  v_add_f32_dpp v32, v21, v32 quad_perm:[1,1,1,1] row_mask:0xf bank_mask:0xf
  v_add_f32_dpp v32, v22, v32 quad_perm:[2,2,2,2] row_mask:0xf bank_mask:0xf
  v_add_f32_dpp v32, v23, v32 quad_perm:[3,3,3,3] row_mask:0xf bank_mask:0xf
  v_cndmask_b32 v27, v27, v32, s[66:67]
  ds_read_b128 v[40:43], v3 offset:10240
  ds_read_b128 v[44:47], v3 offset:11264
  s_waitcnt lgkmcnt(2)
  v_mfma_f32_16x16x32_bf16 v[20:23], v[48:51], v[8:11], 0
  v_mfma_f32_16x16x32_bf16 v[20:23], v[52:55], v[12:15], v[20:23]
  v_mov_b32_dpp v32, v16 quad_perm:[0,0,0,0] row_mask:0xf bank_mask:0xf
  v_add_f32_dpp v32, v17, v32 quad_perm:[1,1,1,1] row_mask:0xf bank_mask:0xf
  v_add_f32_dpp v32, v18, v32 quad_perm:[2,2,2,2] row_mask:0xf bank_mask:0xf
  v_add_f32_dpp v32, v19, v32 quad_perm:[3,3,3,3] row_mask:0xf bank_mask:0xf
  v_cndmask_b32 v27, v27, v32, s[68:69]
  s_waitcnt vmcnt(7)
  buffer_load_dwordx4 v[168:171], v1, s[40:43], s11 offen offset:0 nt
  s_waitcnt vmcnt(7)
  buffer_load_dwordx4 v[172:175], v1, s[40:43], s11 offen offset:256 nt
  s_add_u32 s11, s11, 8192
  ds_read_b128 v[48:51], v3 offset:12288
  ds_read_b128 v[52:55], v3 offset:13312
  s_waitcnt lgkmcnt(2)
  v_mfma_f32_16x16x32_bf16 v[16:19], v[40:43], v[8:11], 0
  v_mfma_f32_16x16x32_bf16 v[16:19], v[44:47], v[12:15], v[16:19]
  v_mov_b32_dpp v32, v20 quad_perm:[0,0,0,0] row_mask:0xf bank_mask:0xf
  v_add_f32_dpp v32, v21, v32 quad_perm:[1,1,1,1] row_mask:0xf bank_mask:0xf
  v_add_f32_dpp v32, v22, v32 quad_perm:[2,2,2,2] row_mask:0xf bank_mask:0xf
  v_add_f32_dpp v32, v23, v32 quad_perm:[3,3,3,3] row_mask:0xf bank_mask:0xf
  v_cndmask_b32 v27, v27, v32, s[70:71]
  ds_read_b128 v[40:43], v3 offset:14336
  ds_read_b128 v[44:47], v3 offset:15360
  s_waitcnt lgkmcnt(2)
  v_mfma_f32_16x16x32_bf16 v[20:23], v[48:51], v[8:11], 0
  v_mfma_f32_16x16x32_bf16 v[20:23], v[52:55], v[12:15], v[20:23]
  v_mov_b32_dpp v32, v16 quad_perm:[0,0,0,0] row_mask:0xf bank_mask:0xf
  v_add_f32_dpp v32, v17, v32 quad_perm:[1,1,1,1] row_mask:0xf bank_mask:0xf
  v_add_f32_dpp v32, v18, v32 quad_perm:[2,2,2,2] row_mask:0xf bank_mask:0xf
  v_add_f32_dpp v32, v19, v32 quad_perm:[3,3,3,3] row_mask:0xf bank_mask:0xf
  v_cndmask_b32 v27, v27, v32, s[72:73]
  s_waitcnt vmcnt(7)
  buffer_load_dwordx4 v[176:179], v1, s[40:43], s11 offen offset:0 nt
  s_waitcnt vmcnt(7)
  buffer_load_dwordx4 v[180:183], v1, s[40:43], s11 offen offset:256 nt
  s_add_u32 s11, s11, 8192
  ds_read_b128 v[48:51], v3 offset:16384
  ds_read_b128 v[52:55], v3 offset:17408
  s_waitcnt lgkmcnt(2)
  v_mfma_f32_16x16x32_bf16 v[16:19], v[40:43], v[8:11], 0
  v_mfma_f32_16x16x32_bf16 v[16:19], v[44:47], v[12:15], v[16:19]
  v_mov_b32_dpp v32, v20 quad_perm:[0,0,0,0] row_mask:0xf bank_mask:0xf
  v_add_f32_dpp v32, v21, v32 quad_perm:[1,1,1,1] row_mask:0xf bank_mask:0xf
  v_add_f32_dpp v32, v22, v32 quad_perm:[2,2,2,2] row_mask:0xf bank_mask:0xf
  v_add_f32_dpp v32, v23, v32 quad_perm:[3,3,3,3] row_mask:0xf bank_mask:0xf
  v_cndmask_b32 v27, v27, v32, s[74:75]
  ds_read_b128 v[40:43], v3 offset:18432
  ds_read_b128 v[44:47], v3 offset:19456
  s_waitcnt lgkmcnt(2)
  v_mfma_f32_16x16x32_bf16 v[20:23], v[48:51], v[8:11], 0
  v_mfma_f32_16x16x32_bf16 v[20:23], v[52:55], v[12:15], v[20:23]
  v_mov_b32_dpp v32, v16 quad_perm:[0,0,0,0] row_mask:0xf bank_mask:0xf
  v_add_f32_dpp v32, v17, v32 quad_perm:[1,1,1,1] row_mask:0xf bank_mask:0xf
  v_add_f32_dpp v32, v18, v32 quad_perm:[2,2,2,2] row_mask:0xf bank_mask:0xf
  v_add_f32_dpp v32, v19, v32 quad_perm:[3,3,3,3] row_mask:0xf bank_mask:0xf
  v_mov_b32 v28, v32
  s_waitcnt vmcnt(7)
  buffer_load_dwordx4 v[184:187], v1, s[40:43], s11 offen offset:0 nt
  s_waitcnt vmcnt(7)
  buffer_load_dwordx4 v[188:191], v1, s[40:43], s11 offen offset:256 nt
  s_add_u32 s11, s11, 8192
  ds_read_b128 v[48:51], v3 offset:20480
  ds_read_b128 v[52:55], v3 offset:21504
  s_waitcnt lgkmcnt(2)
  v_mfma_f32_16x16x32_bf16 v[16:19], v[40:43], v[8:11], 0
  v_mfma_f32_16x16x32_bf16 v[16:19], v[44:47], v[12:15], v[16:19]
  v_mov_b32_dpp v32, v20 quad_perm:[0,0,0,0] row_mask:0xf bank_mask:0xf
  v_add_f32_dpp v32, v21, v32 quad_perm:[1,1,1,1] row_mask:0xf bank_mask:0xf
  v_add_f32_dpp v32, v22, v32 quad_perm:[2,2,2,2] row_mask:0xf bank_mask:0xf
  v_add_f32_dpp v32, v23, v32 quad_perm:[3,3,3,3] row_mask:0xf bank_mask:0xf
  v_cndmask_b32 v28, v28, v32, s[62:63]
  ds_read_b128 v[40:43], v3 offset:22528
  ds_read_b128 v[44:47], v3 offset:23552
  s_waitcnt lgkmcnt(2)
  v_mfma_f32_16x16x32_bf16 v[20:23], v[48:51], v[8:11], 0
  v_mfma_f32_16x16x32_bf16 v[20:23], v[52:55], v[12:15], v[20:23]
  v_mov_b32_dpp v32, v16 quad_perm:[0,0,0,0] row_mask:0xf bank_mask:0xf
  v_add_f32_dpp v32, v17, v32 quad_perm:[1,1,1,1] row_mask:0xf bank_mask:0xf
  v_add_f32_dpp v32, v18, v32 quad_perm:[2,2,2,2] row_mask:0xf bank_mask:0xf
  v_add_f32_dpp v32, v19, v32 quad_perm:[3,3,3,3] row_mask:0xf bank_mask:0xf
  v_cndmask_b32 v28, v28, v32, s[64:65]
  s_waitcnt vmcnt(7)
  buffer_load_dwordx4 v[192:195], v1, s[40:43], s11 offen offset:0 nt
  s_waitcnt vmcnt(7)
  buffer_load_dwordx4 v[196:199], v1, s[40:43], s11 offen offset:256 nt
  s_add_u32 s11, s11, 8192
  ds_read_b128 v[48:51], v3 offset:24576
  ds_read_b128 v[52:55], v3 offset:25600
  s_waitcnt lgkmcnt(2)
  v_mfma_f32_16x16x32_bf16 v[16:19], v[40:43], v[8:11], 0
  v_mfma_f32_16x16x32_bf16 v[16:19], v[44:47], v[12:15], v[16:19]
  v_mov_b32_dpp v32, v20 quad_perm:[0,0,0,0] row_mask:0xf bank_mask:0xf
  v_add_f32_dpp v32, v21, v32 quad_perm:[1,1,1,1] row_mask:0xf bank_mask:0xf
  v_add_f32_dpp v32, v22, v32 quad_perm:[2,2,2,2] row_mask:0xf bank_mask:0xf
  v_add_f32_dpp v32, v23, v32 quad_perm:[3,3,3,3] row_mask:0xf bank_mask:0xf
  v_cndmask_b32 v28, v28, v32, s[66:67]
  ds_read_b128 v[40:43], v3 offset:26624
  ds_read_b128 v[44:47], v3 offset:27648
  s_waitcnt lgkmcnt(2)
  v_mfma_f32_16x16x32_bf16 v[20:23], v[48:51], v[8:11], 0
  v_mfma_f32_16x16x32_bf16 v[20:23], v[52:55], v[12:15], v[20:23]
  v_mov_b32_dpp v32, v16 quad_perm:[0,0,0,0] row_mask:0xf bank_mask:0xf
  v_add_f32_dpp v32, v17, v32 quad_perm:[1,1,1,1] row_mask:0xf bank_mask:0xf
  v_add_f32_dpp v32, v18, v32 quad_perm:[2,2,2,2] row_mask:0xf bank_mask:0xf
  v_add_f32_dpp v32, v19, v32 quad_perm:[3,3,3,3] row_mask:0xf bank_mask:0xf
  v_cndmask_b32 v28, v28, v32, s[68:69]
  s_waitcnt vmcnt(7)
  buffer_load_dwordx4 v[200:203], v1, s[40:43], s11 offen offset:0 nt
  s_waitcnt vmcnt(7)
  buffer_load_dwordx4 v[204:207], v1, s[40:43], s11 offen offset:256 nt
  s_add_u32 s11, s11, 8192
  s_waitcnt lgkmcnt(0)
  v_mfma_f32_16x16x32_bf16 v[16:19], v[40:43], v[8:11], 0
  v_mfma_f32_16x16x32_bf16 v[16:19], v[44:47], v[12:15], v[16:19]
  v_mov_b32_dpp v32, v20 quad_perm:[0,0,0,0] row_mask:0xf bank_mask:0xf
  v_add_f32_dpp v32, v21, v32 quad_perm:[1,1,1,1] row_mask:0xf bank_mask:0xf
  v_add_f32_dpp v32, v22, v32 quad_perm:[2,2,2,2] row_mask:0xf bank_mask:0xf
  v_add_f32_dpp v32, v23, v32 quad_perm:[3,3,3,3] row_mask:0xf bank_mask:0xf
  v_cndmask_b32 v28, v28, v32, s[70:71]
  v_mfma_f32_16x16x32_bf16 v[20:23], v[56:59], v[8:11], 0
  v_mfma_f32_16x16x32_bf16 v[20:23], v[60:63], v[12:15], v[20:23]
  s_nop 0
  v_mov_b32_dpp v32, v16 quad_perm:[0,0,0,0] row_mask:0xf bank_mask:0xf
  v_add_f32_dpp v32, v17, v32 quad_perm:[1,1,1,1] row_mask:0xf bank_mask:0xf
  v_add_f32_dpp v32, v18, v32 quad_perm:[2,2,2,2] row_mask:0xf bank_mask:0xf
  v_add_f32_dpp v32, v19, v32 quad_perm:[3,3,3,3] row_mask:0xf bank_mask:0xf
  v_cndmask_b32 v28, v28, v32, s[72:73]
  s_waitcnt vmcnt(7)
  buffer_load_dwordx4 v[208:211], v1, s[40:43], s11 offen offset:0 nt
  s_waitcnt vmcnt(7)
  buffer_load_dwordx4 v[212:215], v1, s[40:43], s11 offen offset:256 nt
  s_add_u32 s11, s11, 8192
  v_mfma_f32_16x16x32_bf16 v[16:19], v[64:67], v[8:11], 0
  v_mfma_f32_16x16x32_bf16 v[16:19], v[68:71], v[12:15], v[16:19]
  v_mov_b32_dpp v32, v20 quad_perm:[0,0,0,0] row_mask:0xf bank_mask:0xf
  v_add_f32_dpp v32, v21, v32 quad_perm:[1,1,1,1] row_mask:0xf bank_mask:0xf
  v_add_f32_dpp v32, v22, v32 quad_perm:[2,2,2,2] row_mask:0xf bank_mask:0xf
  v_add_f32_dpp v32, v23, v32 quad_perm:[3,3,3,3] row_mask:0xf bank_mask:0xf
  v_cndmask_b32 v28, v28, v32, s[74:75]
  v_mfma_f32_16x16x32_bf16 v[20:23], v[72:75], v[8:11], 0
  v_mfma_f32_16x16x32_bf16 v[20:23], v[76:79], v[12:15], v[20:23]
  s_nop 0
  v_mov_b32_dpp v32, v16 quad_perm:[0,0,0,0] row_mask:0xf bank_mask:0xf
  v_add_f32_dpp v32, v17, v32 quad_perm:[1,1,1,1] row_mask:0xf bank_mask:0xf
  v_add_f32_dpp v32, v18, v32 quad_perm:[2,2,2,2] row_mask:0xf bank_mask:0xf
  v_add_f32_dpp v32, v19, v32 quad_perm:[3,3,3,3] row_mask:0xf bank_mask:0xf
  v_mov_b32 v29, v32
  s_waitcnt vmcnt(7)
  buffer_load_dwordx4 v[216:219], v1, s[40:43], s11 offen offset:0 nt
  s_waitcnt vmcnt(7)
  buffer_load_dwordx4 v[220:223], v1, s[40:43], s11 offen offset:256 nt
  s_add_u32 s11, s11, 8192
  v_mfma_f32_16x16x32_bf16 v[16:19], v[80:83], v[8:11], 0
  v_mfma_f32_16x16x32_bf16 v[16:19], v[84:87], v[12:15], v[16:19]
  v_mov_b32_dpp v32, v20 quad_perm:[0,0,0,0] row_mask:0xf bank_mask:0xf
  v_add_f32_dpp v32, v21, v32 quad_perm:[1,1,1,1] row_mask:0xf bank_mask:0xf
  v_add_f32_dpp v32, v22, v32 quad_perm:[2,2,2,2] row_mask:0xf bank_mask:0xf
  v_add_f32_dpp v32, v23, v32 quad_perm:[3,3,3,3] row_mask:0xf bank_mask:0xf
  v_cndmask_b32 v29, v29, v32, s[62:63]
  v_mfma_f32_16x16x32_bf16 v[20:23], v[88:91], v[8:11], 0
  v_mfma_f32_16x16x32_bf16 v[20:23], v[92:95], v[12:15], v[20:23]
  s_nop 0
  v_mov_b32_dpp v32, v16 quad_perm:[0,0,0,0] row_mask:0xf bank_mask:0xf
  v_add_f32_dpp v32, v17, v32 quad_perm:[1,1,1,1] row_mask:0xf bank_mask:0xf
  v_add_f32_dpp v32, v18, v32 quad_perm:[2,2,2,2] row_mask:0xf bank_mask:0xf
  v_add_f32_dpp v32, v19, v32 quad_perm:[3,3,3,3] row_mask:0xf bank_mask:0xf
  v_cndmask_b32 v29, v29, v32, s[64:65]
  s_waitcnt vmcnt(7)
  buffer_load_dwordx4 v[224:227], v1, s[40:43], s11 offen offset:0 nt
  s_waitcnt vmcnt(7)
  buffer_load_dwordx4 v[228:231], v1, s[40:43], s11 offen offset:256 nt
  s_add_u32 s11, s11, 8192
  v_mfma_f32_16x16x32_bf16 v[16:19], v[96:99], v[8:11], 0
  v_mfma_f32_16x16x32_bf16 v[16:19], v[100:103], v[12:15], v[16:19]
  v_mov_b32_dpp v32, v20 quad_perm:[0,0,0,0] row_mask:0xf bank_mask:0xf
  v_add_f32_dpp v32, v21, v32 quad_perm:[1,1,1,1] row_mask:0xf bank_mask:0xf
  v_add_f32_dpp v32, v22, v32 quad_perm:[2,2,2,2] row_mask:0xf bank_mask:0xf
  v_add_f32_dpp v32, v23, v32 quad_perm:[3,3,3,3] row_mask:0xf bank_mask:0xf
  v_cndmask_b32 v29, v29, v32, s[66:67]
  v_mfma_f32_16x16x32_bf16 v[20:23], v[104:107], v[8:11], 0
  v_mfma_f32_16x16x32_bf16 v[20:23], v[108:111], v[12:15], v[20:23]
  s_nop 0
  v_mov_b32_dpp v32, v16 quad_perm:[0,0,0,0] row_mask:0xf bank_mask:0xf
  v_add_f32_dpp v32, v17, v32 quad_perm:[1,1,1,1] row_mask:0xf bank_mask:0xf
  v_add_f32_dpp v32, v18, v32 quad_perm:[2,2,2,2] row_mask:0xf bank_mask:0xf
  v_add_f32_dpp v32, v19, v32 quad_perm:[3,3,3,3] row_mask:0xf bank_mask:0xf
  v_cndmask_b32 v29, v29, v32, s[68:69]
  s_waitcnt vmcnt(7)
  buffer_load_dwordx4 v[232:235], v1, s[40:43], s11 offen offset:0 nt
  s_waitcnt vmcnt(7)
  buffer_load_dwordx4 v[236:239], v1, s[40:43], s11 offen offset:256 nt
  s_add_u32 s11, s11, 8192
  v_mfma_f32_16x16x32_bf16 v[16:19], v[112:115], v[8:11], 0
  v_mfma_f32_16x16x32_bf16 v[16:19], v[116:119], v[12:15], v[16:19]
  v_mov_b32_dpp v32, v20 quad_perm:[0,0,0,0] row_mask:0xf bank_mask:0xf
  v_add_f32_dpp v32, v21, v32 quad_perm:[1,1,1,1] row_mask:0xf bank_mask:0xf
  v_add_f32_dpp v32, v22, v32 quad_perm:[2,2,2,2] row_mask:0xf bank_mask:0xf
  v_add_f32_dpp v32, v23, v32 quad_perm:[3,3,3,3] row_mask:0xf bank_mask:0xf
  v_cndmask_b32 v29, v29, v32, s[70:71]
  v_mfma_f32_16x16x32_bf16 v[20:23], v[120:123], v[8:11], 0
  v_mfma_f32_16x16x32_bf16 v[20:23], v[124:127], v[12:15], v[20:23]
  s_nop 0
  v_mov_b32_dpp v32, v16 quad_perm:[0,0,0,0] row_mask:0xf bank_mask:0xf
  v_add_f32_dpp v32, v17, v32 quad_perm:[1,1,1,1] row_mask:0xf bank_mask:0xf
  v_add_f32_dpp v32, v18, v32 quad_perm:[2,2,2,2] row_mask:0xf bank_mask:0xf
  v_add_f32_dpp v32, v19, v32 quad_perm:[3,3,3,3] row_mask:0xf bank_mask:0xf
  v_cndmask_b32 v29, v29, v32, s[72:73]
  s_waitcnt vmcnt(7)
  buffer_load_dwordx4 v[240:243], v1, s[40:43], s11 offen offset:0 nt
  s_waitcnt vmcnt(7)
  buffer_load_dwordx4 v[244:247], v1, s[40:43], s11 offen offset:256 nt
  s_add_u32 s11, s11, 8192
  v_mfma_f32_16x16x32_bf16 v[16:19], v[128:131], v[8:11], 0
  v_mfma_f32_16x16x32_bf16 v[16:19], v[132:135], v[12:15], v[16:19]
  v_mov_b32_dpp v32, v20 quad_perm:[0,0,0,0] row_mask:0xf bank_mask:0xf
  v_add_f32_dpp v32, v21, v32 quad_perm:[1,1,1,1] row_mask:0xf bank_mask:0xf
  v_add_f32_dpp v32, v22, v32 quad_perm:[2,2,2,2] row_mask:0xf bank_mask:0xf
  v_add_f32_dpp v32, v23, v32 quad_perm:[3,3,3,3] row_mask:0xf bank_mask:0xf
  v_cndmask_b32 v29, v29, v32, s[74:75]
  v_mfma_f32_16x16x32_bf16 v[20:23], v[136:139], v[8:11], 0
  v_mfma_f32_16x16x32_bf16 v[20:23], v[140:143], v[12:15], v[20:23]
  s_nop 0
  v_mov_b32_dpp v32, v16 quad_perm:[0,0,0,0] row_mask:0xf bank_mask:0xf
  v_add_f32_dpp v32, v17, v32 quad_perm:[1,1,1,1] row_mask:0xf bank_mask:0xf
  v_add_f32_dpp v32, v18, v32 quad_perm:[2,2,2,2] row_mask:0xf bank_mask:0xf
  v_add_f32_dpp v32, v19, v32 quad_perm:[3,3,3,3] row_mask:0xf bank_mask:0xf
  v_mov_b32 v30, v32
  s_waitcnt vmcnt(7)
  buffer_load_dwordx4 v[248:251], v1, s[40:43], s11 offen offset:0 nt
  s_waitcnt vmcnt(7)
  buffer_load_dwordx4 v[252:255], v1, s[40:43], s11 offen offset:256 nt
  s_add_u32 s11, s11, 8192
  v_mfma_f32_16x16x32_bf16 v[16:19], v[144:147], v[8:11], 0
  v_mfma_f32_16x16x32_bf16 v[16:19], v[148:151], v[12:15], v[16:19]
  v_mov_b32_dpp v32, v20 quad_perm:[0,0,0,0] row_mask:0xf bank_mask:0xf
  v_add_f32_dpp v32, v21, v32 quad_perm:[1,1,1,1] row_mask:0xf bank_mask:0xf
  v_add_f32_dpp v32, v22, v32 quad_perm:[2,2,2,2] row_mask:0xf bank_mask:0xf
  v_add_f32_dpp v32, v23, v32 quad_perm:[3,3,3,3] row_mask:0xf bank_mask:0xf
  v_cndmask_b32 v30, v30, v32, s[62:63]
  v_mfma_f32_16x16x32_bf16 v[20:23], v[152:155], v[8:11], 0
  v_mfma_f32_16x16x32_bf16 v[20:23], v[156:159], v[12:15], v[20:23]
  s_nop 0
  v_mov_b32_dpp v32, v16 quad_perm:[0,0,0,0] row_mask:0xf bank_mask:0xf
  v_add_f32_dpp v32, v17, v32 quad_perm:[1,1,1,1] row_mask:0xf bank_mask:0xf
  v_add_f32_dpp v32, v18, v32 quad_perm:[2,2,2,2] row_mask:0xf bank_mask:0xf
  v_add_f32_dpp v32, v19, v32 quad_perm:[3,3,3,3] row_mask:0xf bank_mask:0xf
  v_cndmask_b32 v30, v30, v32, s[64:65]
  s_waitcnt vmcnt(7)
  buffer_load_dwordx4 v[56:59], v2, s[44:47], s12 offen offset:0 nt
  s_waitcnt vmcnt(7)
  buffer_load_dwordx4 v[60:63], v2, s[44:47], s12 offen offset:256 nt
  s_add_u32 s12, s12, 8192
  v_mfma_f32_16x16x32_bf16 v[16:19], v[160:163], v[8:11], 0
  v_mfma_f32_16x16x32_bf16 v[16:19], v[164:167], v[12:15], v[16:19]
  v_mov_b32_dpp v32, v20 quad_perm:[0,0,0,0] row_mask:0xf bank_mask:0xf
  v_add_f32_dpp v32, v21, v32 quad_perm:[1,1,1,1] row_mask:0xf bank_mask:0xf
  v_add_f32_dpp v32, v22, v32 quad_perm:[2,2,2,2] row_mask:0xf bank_mask:0xf
  v_add_f32_dpp v32, v23, v32 quad_perm:[3,3,3,3] row_mask:0xf bank_mask:0xf
  v_cndmask_b32 v30, v30, v32, s[66:67]
  v_mfma_f32_16x16x32_bf16 v[20:23], v[168:171], v[8:11], 0
  v_mfma_f32_16x16x32_bf16 v[20:23], v[172:175], v[12:15], v[20:23]
  s_nop 0
  v_mov_b32_dpp v32, v16 quad_perm:[0,0,0,0] row_mask:0xf bank_mask:0xf
  v_add_f32_dpp v32, v17, v32 quad_perm:[1,1,1,1] row_mask:0xf bank_mask:0xf
  v_add_f32_dpp v32, v18, v32 quad_perm:[2,2,2,2] row_mask:0xf bank_mask:0xf
  v_add_f32_dpp v32, v19, v32 quad_perm:[3,3,3,3] row_mask:0xf bank_mask:0xf
  v_cndmask_b32 v30, v30, v32, s[68:69]
  s_waitcnt vmcnt(7)
  buffer_load_dwordx4 v[64:67], v2, s[44:47], s12 offen offset:0 nt
  s_waitcnt vmcnt(7)
  buffer_load_dwordx4 v[68:71], v2, s[44:47], s12 offen offset:256 nt
  s_add_u32 s12, s12, 8192
  v_mfma_f32_16x16x32_bf16 v[16:19], v[176:179], v[8:11], 0
  v_mfma_f32_16x16x32_bf16 v[16:19], v[180:183], v[12:15], v[16:19]
  v_mov_b32_dpp v32, v20 quad_perm:[0,0,0,0] row_mask:0xf bank_mask:0xf
  v_add_f32_dpp v32, v21, v32 quad_perm:[1,1,1,1] row_mask:0xf bank_mask:0xf
  v_add_f32_dpp v32, v22, v32 quad_perm:[2,2,2,2] row_mask:0xf bank_mask:0xf
  v_add_f32_dpp v32, v23, v32 quad_perm:[3,3,3,3] row_mask:0xf bank_mask:0xf
  v_cndmask_b32 v30, v30, v32, s[70:71]
  v_mfma_f32_16x16x32_bf16 v[20:23], v[184:187], v[8:11], 0
  v_mfma_f32_16x16x32_bf16 v[20:23], v[188:191], v[12:15], v[20:23]
  s_nop 0
  v_mov_b32_dpp v32, v16 quad_perm:[0,0,0,0] row_mask:0xf bank_mask:0xf
  v_add_f32_dpp v32, v17, v32 quad_perm:[1,1,1,1] row_mask:0xf bank_mask:0xf
  v_add_f32_dpp v32, v18, v32 quad_perm:[2,2,2,2] row_mask:0xf bank_mask:0xf
  v_add_f32_dpp v32, v19, v32 quad_perm:[3,3,3,3] row_mask:0xf bank_mask:0xf
  v_cndmask_b32 v30, v30, v32, s[72:73]
  s_waitcnt vmcnt(7)
  buffer_load_dwordx4 v[72:75], v2, s[44:47], s12 offen offset:0 nt
  s_waitcnt vmcnt(7)
  buffer_load_dwordx4 v[76:79], v2, s[44:47], s12 offen offset:256 nt
  s_add_u32 s12, s12, 8192
  v_mfma_f32_16x16x32_bf16 v[16:19], v[192:195], v[8:11], 0
  v_mfma_f32_16x16x32_bf16 v[16:19], v[196:199], v[12:15], v[16:19]
  v_mov_b32_dpp v32, v20 quad_perm:[0,0,0,0] row_mask:0xf bank_mask:0xf
  v_add_f32_dpp v32, v21, v32 quad_perm:[1,1,1,1] row_mask:0xf bank_mask:0xf
  v_add_f32_dpp v32, v22, v32 quad_perm:[2,2,2,2] row_mask:0xf bank_mask:0xf
  v_add_f32_dpp v32, v23, v32 quad_perm:[3,3,3,3] row_mask:0xf bank_mask:0xf
  v_cndmask_b32 v30, v30, v32, s[74:75]
  v_mfma_f32_16x16x32_bf16 v[20:23], v[200:203], v[8:11], 0
  v_mfma_f32_16x16x32_bf16 v[20:23], v[204:207], v[12:15], v[20:23]
  s_nop 0
  v_mov_b32_dpp v32, v16 quad_perm:[0,0,0,0] row_mask:0xf bank_mask:0xf
  v_add_f32_dpp v32, v17, v32 quad_perm:[1,1,1,1] row_mask:0xf bank_mask:0xf
  v_add_f32_dpp v32, v18, v32 quad_perm:[2,2,2,2] row_mask:0xf bank_mask:0xf
  v_add_f32_dpp v32, v19, v32 quad_perm:[3,3,3,3] row_mask:0xf bank_mask:0xf
  v_mov_b32 v31, v32
  s_waitcnt vmcnt(7)
  buffer_load_dwordx4 v[80:83], v2, s[44:47], s12 offen offset:0 nt
  s_waitcnt vmcnt(7)
  buffer_load_dwordx4 v[84:87], v2, s[44:47], s12 offen offset:256 nt
  s_add_u32 s12, s12, 8192
  v_mfma_f32_16x16x32_bf16 v[16:19], v[208:211], v[8:11], 0
  v_mfma_f32_16x16x32_bf16 v[16:19], v[212:215], v[12:15], v[16:19]
  v_mov_b32_dpp v32, v20 quad_perm:[0,0,0,0] row_mask:0xf bank_mask:0xf
  v_add_f32_dpp v32, v21, v32 quad_perm:[1,1,1,1] row_mask:0xf bank_mask:0xf
  v_add_f32_dpp v32, v22, v32 quad_perm:[2,2,2,2] row_mask:0xf bank_mask:0xf
  v_add_f32_dpp v32, v23, v32 quad_perm:[3,3,3,3] row_mask:0xf bank_mask:0xf
  v_cndmask_b32 v31, v31, v32, s[62:63]
  v_mfma_f32_16x16x32_bf16 v[20:23], v[216:219], v[8:11], 0
  v_mfma_f32_16x16x32_bf16 v[20:23], v[220:223], v[12:15], v[20:23]
  s_nop 0
  v_mov_b32_dpp v32, v16 quad_perm:[0,0,0,0] row_mask:0xf bank_mask:0xf
  v_add_f32_dpp v32, v17, v32 quad_perm:[1,1,1,1] row_mask:0xf bank_mask:0xf
  v_add_f32_dpp v32, v18, v32 quad_perm:[2,2,2,2] row_mask:0xf bank_mask:0xf
  v_add_f32_dpp v32, v19, v32 quad_perm:[3,3,3,3] row_mask:0xf bank_mask:0xf
  v_cndmask_b32 v31, v31, v32, s[64:65]
  s_waitcnt vmcnt(7)
  buffer_load_dwordx4 v[88:91], v2, s[44:47], s12 offen offset:0 nt
  s_waitcnt vmcnt(7)
  buffer_load_dwordx4 v[92:95], v2, s[44:47], s12 offen offset:256 nt
  s_add_u32 s12, s12, 8192
  v_mfma_f32_16x16x32_bf16 v[16:19], v[224:227], v[8:11], 0
  v_mfma_f32_16x16x32_bf16 v[16:19], v[228:231], v[12:15], v[16:19]
  v_mov_b32_dpp v32, v20 quad_perm:[0,0,0,0] row_mask:0xf bank_mask:0xf
  v_add_f32_dpp v32, v21, v32 quad_perm:[1,1,1,1] row_mask:0xf bank_mask:0xf
  v_add_f32_dpp v32, v22, v32 quad_perm:[2,2,2,2] row_mask:0xf bank_mask:0xf
  v_add_f32_dpp v32, v23, v32 quad_perm:[3,3,3,3] row_mask:0xf bank_mask:0xf
  v_cndmask_b32 v31, v31, v32, s[66:67]
  v_mfma_f32_16x16x32_bf16 v[20:23], v[232:235], v[8:11], 0
  v_mfma_f32_16x16x32_bf16 v[20:23], v[236:239], v[12:15], v[20:23]
  s_nop 0
  v_mov_b32_dpp v32, v16 quad_perm:[0,0,0,0] row_mask:0xf bank_mask:0xf
  v_add_f32_dpp v32, v17, v32 quad_perm:[1,1,1,1] row_mask:0xf bank_mask:0xf
  v_add_f32_dpp v32, v18, v32 quad_perm:[2,2,2,2] row_mask:0xf bank_mask:0xf
  v_add_f32_dpp v32, v19, v32 quad_perm:[3,3,3,3] row_mask:0xf bank_mask:0xf
  v_cndmask_b32 v31, v31, v32, s[68:69]
  s_waitcnt vmcnt(7)
  buffer_load_dwordx4 v[96:99], v2, s[44:47], s12 offen offset:0 nt
  s_waitcnt vmcnt(7)
  buffer_load_dwordx4 v[100:103], v2, s[44:47], s12 offen offset:256 nt
  s_add_u32 s12, s12, 8192
  v_mfma_f32_16x16x32_bf16 v[16:19], v[240:243], v[8:11], 0
  v_mfma_f32_16x16x32_bf16 v[16:19], v[244:247], v[12:15], v[16:19]
  v_mov_b32_dpp v32, v20 quad_perm:[0,0,0,0] row_mask:0xf bank_mask:0xf
  v_add_f32_dpp v32, v21, v32 quad_perm:[1,1,1,1] row_mask:0xf bank_mask:0xf
  v_add_f32_dpp v32, v22, v32 quad_perm:[2,2,2,2] row_mask:0xf bank_mask:0xf
  v_add_f32_dpp v32, v23, v32 quad_perm:[3,3,3,3] row_mask:0xf bank_mask:0xf
  v_cndmask_b32 v31, v31, v32, s[70:71]
  v_mfma_f32_16x16x32_bf16 v[20:23], v[248:251], v[8:11], 0
  v_mfma_f32_16x16x32_bf16 v[20:23], v[252:255], v[12:15], v[20:23]
  s_nop 0
  v_mov_b32_dpp v32, v16 quad_perm:[0,0,0,0] row_mask:0xf bank_mask:0xf
  v_add_f32_dpp v32, v17, v32 quad_perm:[1,1,1,1] row_mask:0xf bank_mask:0xf
  v_add_f32_dpp v32, v18, v32 quad_perm:[2,2,2,2] row_mask:0xf bank_mask:0xf
  v_add_f32_dpp v32, v19, v32 quad_perm:[3,3,3,3] row_mask:0xf bank_mask:0xf
  v_cndmask_b32 v31, v31, v32, s[72:73]
  s_waitcnt vmcnt(7)
  buffer_load_dwordx4 v[104:107], v2, s[44:47], s12 offen offset:0 nt
  s_waitcnt vmcnt(7)
  buffer_load_dwordx4 v[108:111], v2, s[44:47], s12 offen offset:256 nt
  s_add_u32 s12, s12, 8192
  v_mov_b32_dpp v32, v20 quad_perm:[0,0,0,0] row_mask:0xf bank_mask:0xf
  v_add_f32_dpp v32, v21, v32 quad_perm:[1,1,1,1] row_mask:0xf bank_mask:0xf
  v_add_f32_dpp v32, v22, v32 quad_perm:[2,2,2,2] row_mask:0xf bank_mask:0xf
  v_add_f32_dpp v32, v23, v32 quad_perm:[3,3,3,3] row_mask:0xf bank_mask:0xf
  v_cndmask_b32 v31, v31, v32, s[74:75]
  v_max3_f32 v34, v24, v25, v26
  v_max3_f32 v34, v34, v27, v28
  v_max3_f32 v34, v34, v29, v30
  v_max_f32 v34, v34, v31
  s_nop 1
  v_max_f32_dpp v34, v34, v34 quad_perm:[1,0,3,2] row_mask:0xf bank_mask:0xf
  s_nop 1
  v_max_f32_dpp v34, v34, v34 quad_perm:[2,3,0,1] row_mask:0xf bank_mask:0xf
  s_nop 1
  v_max_f32_dpp v34, v34, v34 row_half_mirror row_mask:0xf bank_mask:0xf
  v_mov_b32 v32, v34
  v_mov_b32 v33, v34
  s_nop 1
  v_permlane16_swap_b32 v32, v33
  v_max_f32 v34, v32, v33
  v_mov_b32 v32, v34
  v_mov_b32 v33, v34
  s_nop 1
  v_permlane32_swap_b32 v32, v33
  v_max_f32 v34, v32, v33
  s_mov_b32 s13, 0x3db8aa3b
  v_mul_f32 v34, s13, v34
  v_fma_f32 v24, v24, s13, -v34
  v_fma_f32 v25, v25, s13, -v34
  v_fma_f32 v26, v26, s13, -v34
  v_fma_f32 v27, v27, s13, -v34
  v_fma_f32 v28, v28, s13, -v34
  v_fma_f32 v29, v29, s13, -v34
  v_fma_f32 v30, v30, s13, -v34
  v_fma_f32 v31, v31, s13, -v34
  v_exp_f32 v24, v24
  v_exp_f32 v25, v25
  v_exp_f32 v26, v26
  v_exp_f32 v27, v27
  v_exp_f32 v28, v28
  v_exp_f32 v29, v29
  v_exp_f32 v30, v30
  v_exp_f32 v31, v31
  v_add_f32 v35, v24, v25
  v_add_f32 v35, v35, v26
  v_add_f32 v35, v35, v27
  v_add_f32 v35, v35, v28
  v_add_f32 v35, v35, v29
  v_add_f32 v35, v35, v30
  v_add_f32 v35, v35, v31
  v_cvt_pk_bf16_f32 v24, v24, v24
  v_cvt_pk_bf16_f32 v25, v25, v25
  v_cvt_pk_bf16_f32 v26, v26, v26
  v_cvt_pk_bf16_f32 v27, v27, v27
  v_cvt_pk_bf16_f32 v28, v28, v28
  v_cvt_pk_bf16_f32 v29, v29, v29
  v_cvt_pk_bf16_f32 v30, v30, v30
  v_cvt_pk_bf16_f32 v31, v31, v31
  v_add_f32_dpp v35, v35, v35 quad_perm:[1,0,3,2] row_mask:0xf bank_mask:0xf
  s_nop 1
  v_add_f32_dpp v35, v35, v35 quad_perm:[2,3,0,1] row_mask:0xf bank_mask:0xf
  s_nop 1
  v_add_f32_dpp v35, v35, v35 row_half_mirror row_mask:0xf bank_mask:0xf
  v_mov_b32 v32, v35
  v_mov_b32 v33, v35
  s_nop 1
  v_permlane16_swap_b32 v32, v33
  v_add_f32 v35, v32, v33
  v_mov_b32 v32, v35
  v_mov_b32 v33, v35
  s_nop 1
  v_permlane32_swap_b32 v32, v33
  v_add_f32 v35, v32, v33
  v_bfe_u32 v36, v0, 3, 1
  v_lshlrev_b32 v36, 5, v36
  s_lshl_b32 s13, s3, 3
  s_add_u32 s13, s13, 160768
  v_add_u32 v36, s13, v36
  ds_write_b64 v36, v[34:35]
  s_lshl_b32 s13, s3, 2
  v_add_u32 v37, s13, v37
  v_mov_b32 v36, 1
  s_waitcnt lgkmcnt(0)
  ds_write_b32 v37, v36 offset:8
  s_lshr_b32 s70, s3, 2
  s_bfe_u32 s71, s3, 0x10001
  s_and_b32 s72, s3, 1
  s_lshl_b32 s73, s71, 10
  s_lshl_b32 s74, s72, 9
  s_add_u32 s73, s73, s74
  s_lshl_b32 s74, s70, 7
  s_add_u32 s73, s73, s74
  v_lshrrev_b32 v38, 5, v0
  v_lshlrev_b32 v38, 8, v38
  v_and_b32 v39, 7, v0
  v_lshl_add_u32 v38, v39, 4, v38
  v_bfe_u32 v39, v0, 3, 2
  v_lshl_add_u32 v38, v39, 2, v38
  v_add_u32 v38, s73, v38
  s_lshl_b32 s73, s9, 11
  s_lshl_b32 s74, s3, 8
  s_add_u32 s73, s73, s74
  s_add_u32 s73, s73, 1048576
  v_lshlrev_b32 v39, 2, v0
  v_add_u32 v39, s73, v39
  s_lshl_b32 s74, s70, 4
  s_add_u32 s74, s74, 160832
  v_mov_b32 v37, s74
  v_mov_b32_dpp v32, v24 row_newbcast:0 row_mask:0xf bank_mask:0x3
  v_mov_b32_dpp v32, v24 row_newbcast:8 row_mask:0xf bank_mask:0xc
  v_and_b32 v8, v32, v4
  v_and_b32 v9, v32, v5
  v_and_b32 v10, v32, v6
  v_and_b32 v11, v32, v7
  s_nop 1
  v_mfma_f32_16x16x32_bf16 v[16:19], v[56:59], v[8:11], 0
  v_mfma_f32_16x16x32_bf16 v[20:23], v[60:63], v[8:11], 0
  v_mov_b32_dpp v33, v24 row_newbcast:1 row_mask:0xf bank_mask:0x3
  v_mov_b32_dpp v33, v24 row_newbcast:9 row_mask:0xf bank_mask:0xc
  v_and_b32 v12, v33, v4
  v_and_b32 v13, v33, v5
  v_and_b32 v14, v33, v6
  v_and_b32 v15, v33, v7
  s_nop 1
  v_mfma_f32_16x16x32_bf16 v[16:19], v[64:67], v[12:15], v[16:19]
  v_mfma_f32_16x16x32_bf16 v[20:23], v[68:71], v[12:15], v[20:23]
  v_mov_b32_dpp v32, v24 row_newbcast:2 row_mask:0xf bank_mask:0x3
  v_mov_b32_dpp v32, v24 row_newbcast:10 row_mask:0xf bank_mask:0xc
  v_and_b32 v8, v32, v4
  v_and_b32 v9, v32, v5
  v_and_b32 v10, v32, v6
  v_and_b32 v11, v32, v7
  s_waitcnt vmcnt(7)
  buffer_load_dwordx4 v[112:115], v2, s[44:47], s12 offen offset:0 nt
  s_waitcnt vmcnt(7)
  buffer_load_dwordx4 v[116:119], v2, s[44:47], s12 offen offset:256 nt
  s_add_u32 s12, s12, 8192
  v_mfma_f32_16x16x32_bf16 v[16:19], v[72:75], v[8:11], v[16:19]
  v_mfma_f32_16x16x32_bf16 v[20:23], v[76:79], v[8:11], v[20:23]
  v_mov_b32_dpp v33, v24 row_newbcast:3 row_mask:0xf bank_mask:0x3
  v_mov_b32_dpp v33, v24 row_newbcast:11 row_mask:0xf bank_mask:0xc
  v_and_b32 v12, v33, v4
  v_and_b32 v13, v33, v5
  v_and_b32 v14, v33, v6
  v_and_b32 v15, v33, v7
  s_nop 1
  v_mfma_f32_16x16x32_bf16 v[16:19], v[80:83], v[12:15], v[16:19]
  v_mfma_f32_16x16x32_bf16 v[20:23], v[84:87], v[12:15], v[20:23]
  v_mov_b32_dpp v32, v24 row_newbcast:4 row_mask:0xf bank_mask:0x3
  v_mov_b32_dpp v32, v24 row_newbcast:12 row_mask:0xf bank_mask:0xc
  v_and_b32 v8, v32, v4
  v_and_b32 v9, v32, v5
  v_and_b32 v10, v32, v6
  v_and_b32 v11, v32, v7
  s_waitcnt vmcnt(7)
  buffer_load_dwordx4 v[120:123], v2, s[44:47], s12 offen offset:0 nt
  s_waitcnt vmcnt(7)
  buffer_load_dwordx4 v[124:127], v2, s[44:47], s12 offen offset:256 nt
  s_add_u32 s12, s12, 8192
  v_mfma_f32_16x16x32_bf16 v[16:19], v[88:91], v[8:11], v[16:19]
  v_mfma_f32_16x16x32_bf16 v[20:23], v[92:95], v[8:11], v[20:23]
  v_mov_b32_dpp v33, v24 row_newbcast:5 row_mask:0xf bank_mask:0x3
  v_mov_b32_dpp v33, v24 row_newbcast:13 row_mask:0xf bank_mask:0xc
  v_and_b32 v12, v33, v4
  v_and_b32 v13, v33, v5
  v_and_b32 v14, v33, v6
  v_and_b32 v15, v33, v7
  s_waitcnt vmcnt(7)
  buffer_load_dwordx4 v[128:131], v2, s[44:47], s12 offen offset:0 nt
  s_waitcnt vmcnt(7)
  buffer_load_dwordx4 v[132:135], v2, s[44:47], s12 offen offset:256 nt
  s_add_u32 s12, s12, 8192
  v_mfma_f32_16x16x32_bf16 v[16:19], v[96:99], v[12:15], v[16:19]
  v_mfma_f32_16x16x32_bf16 v[20:23], v[100:103], v[12:15], v[20:23]
  v_mov_b32_dpp v32, v24 row_newbcast:6 row_mask:0xf bank_mask:0x3
  v_mov_b32_dpp v32, v24 row_newbcast:14 row_mask:0xf bank_mask:0xc
  v_and_b32 v8, v32, v4
  v_and_b32 v9, v32, v5
  v_and_b32 v10, v32, v6
  v_and_b32 v11, v32, v7
  s_waitcnt vmcnt(7)
  buffer_load_dwordx4 v[136:139], v2, s[44:47], s12 offen offset:0 nt
  s_waitcnt vmcnt(7)
  buffer_load_dwordx4 v[140:143], v2, s[44:47], s12 offen offset:256 nt
  s_add_u32 s12, s12, 8192
  v_mfma_f32_16x16x32_bf16 v[16:19], v[104:107], v[8:11], v[16:19]
  v_mfma_f32_16x16x32_bf16 v[20:23], v[108:111], v[8:11], v[20:23]
  v_mov_b32_dpp v33, v24 row_newbcast:7 row_mask:0xf bank_mask:0x3
  v_mov_b32_dpp v33, v24 row_newbcast:15 row_mask:0xf bank_mask:0xc
  v_and_b32 v12, v33, v4
  v_and_b32 v13, v33, v5
  v_and_b32 v14, v33, v6
  v_and_b32 v15, v33, v7
  s_waitcnt vmcnt(7)
  buffer_load_dwordx4 v[144:147], v2, s[44:47], s12 offen offset:0 nt
  s_waitcnt vmcnt(7)
  buffer_load_dwordx4 v[148:151], v2, s[44:47], s12 offen offset:256 nt
  s_add_u32 s12, s12, 8192
  v_mfma_f32_16x16x32_bf16 v[16:19], v[112:115], v[12:15], v[16:19]
  v_mfma_f32_16x16x32_bf16 v[20:23], v[116:119], v[12:15], v[20:23]
  v_mov_b32_dpp v32, v25 row_newbcast:0 row_mask:0xf bank_mask:0x3
  v_mov_b32_dpp v32, v25 row_newbcast:8 row_mask:0xf bank_mask:0xc
  v_and_b32 v8, v32, v4
  v_and_b32 v9, v32, v5
  v_and_b32 v10, v32, v6
  v_and_b32 v11, v32, v7
  s_waitcnt vmcnt(7)
  buffer_load_dwordx4 v[152:155], v2, s[44:47], s12 offen offset:0 nt
  s_waitcnt vmcnt(7)
  buffer_load_dwordx4 v[156:159], v2, s[44:47], s12 offen offset:256 nt
  s_add_u32 s12, s12, 8192
  v_mfma_f32_16x16x32_bf16 v[16:19], v[120:123], v[8:11], v[16:19]
  v_mfma_f32_16x16x32_bf16 v[20:23], v[124:127], v[8:11], v[20:23]
  v_mov_b32_dpp v33, v25 row_newbcast:1 row_mask:0xf bank_mask:0x3
  v_mov_b32_dpp v33, v25 row_newbcast:9 row_mask:0xf bank_mask:0xc
  v_and_b32 v12, v33, v4
  v_and_b32 v13, v33, v5
  v_and_b32 v14, v33, v6
  v_and_b32 v15, v33, v7
  s_waitcnt vmcnt(7)
  buffer_load_dwordx4 v[160:163], v2, s[44:47], s12 offen offset:0 nt
  s_waitcnt vmcnt(7)
  buffer_load_dwordx4 v[164:167], v2, s[44:47], s12 offen offset:256 nt
  s_add_u32 s12, s12, 8192
  v_mfma_f32_16x16x32_bf16 v[16:19], v[128:131], v[12:15], v[16:19]
  v_mfma_f32_16x16x32_bf16 v[20:23], v[132:135], v[12:15], v[20:23]
  v_mov_b32_dpp v32, v25 row_newbcast:2 row_mask:0xf bank_mask:0x3
  v_mov_b32_dpp v32, v25 row_newbcast:10 row_mask:0xf bank_mask:0xc
  v_and_b32 v8, v32, v4
  v_and_b32 v9, v32, v5
  v_and_b32 v10, v32, v6
  v_and_b32 v11, v32, v7
  s_waitcnt vmcnt(7)
  buffer_load_dwordx4 v[168:171], v2, s[44:47], s12 offen offset:0 nt
  s_waitcnt vmcnt(7)
  buffer_load_dwordx4 v[172:175], v2, s[44:47], s12 offen offset:256 nt
  s_add_u32 s12, s12, 8192
  v_mfma_f32_16x16x32_bf16 v[16:19], v[136:139], v[8:11], v[16:19]
  v_mfma_f32_16x16x32_bf16 v[20:23], v[140:143], v[8:11], v[20:23]
  v_mov_b32_dpp v33, v25 row_newbcast:3 row_mask:0xf bank_mask:0x3
  v_mov_b32_dpp v33, v25 row_newbcast:11 row_mask:0xf bank_mask:0xc
  v_and_b32 v12, v33, v4
  v_and_b32 v13, v33, v5
  v_and_b32 v14, v33, v6
  v_and_b32 v15, v33, v7
  s_waitcnt vmcnt(7)
  buffer_load_dwordx4 v[176:179], v2, s[44:47], s12 offen offset:0 nt
  s_waitcnt vmcnt(7)
  buffer_load_dwordx4 v[180:183], v2, s[44:47], s12 offen offset:256 nt
  s_add_u32 s12, s12, 8192
  v_mfma_f32_16x16x32_bf16 v[16:19], v[144:147], v[12:15], v[16:19]
  v_mfma_f32_16x16x32_bf16 v[20:23], v[148:151], v[12:15], v[20:23]
  v_mov_b32_dpp v32, v25 row_newbcast:4 row_mask:0xf bank_mask:0x3
  v_mov_b32_dpp v32, v25 row_newbcast:12 row_mask:0xf bank_mask:0xc
  v_and_b32 v8, v32, v4
  v_and_b32 v9, v32, v5
  v_and_b32 v10, v32, v6
  v_and_b32 v11, v32, v7
  s_waitcnt vmcnt(7)
  buffer_load_dwordx4 v[184:187], v2, s[44:47], s12 offen offset:0 nt
  s_waitcnt vmcnt(7)
  buffer_load_dwordx4 v[188:191], v2, s[44:47], s12 offen offset:256 nt
  s_add_u32 s12, s12, 8192
  v_mfma_f32_16x16x32_bf16 v[16:19], v[152:155], v[8:11], v[16:19]
  v_mfma_f32_16x16x32_bf16 v[20:23], v[156:159], v[8:11], v[20:23]
  v_mov_b32_dpp v33, v25 row_newbcast:5 row_mask:0xf bank_mask:0x3
  v_mov_b32_dpp v33, v25 row_newbcast:13 row_mask:0xf bank_mask:0xc
  v_and_b32 v12, v33, v4
  v_and_b32 v13, v33, v5
  v_and_b32 v14, v33, v6
  v_and_b32 v15, v33, v7
  s_waitcnt vmcnt(7)
  buffer_load_dwordx4 v[192:195], v2, s[44:47], s12 offen offset:0 nt
  s_waitcnt vmcnt(7)
  buffer_load_dwordx4 v[196:199], v2, s[44:47], s12 offen offset:256 nt
  s_add_u32 s12, s12, 8192
  v_mfma_f32_16x16x32_bf16 v[16:19], v[160:163], v[12:15], v[16:19]
  v_mfma_f32_16x16x32_bf16 v[20:23], v[164:167], v[12:15], v[20:23]
  v_mov_b32_dpp v32, v25 row_newbcast:6 row_mask:0xf bank_mask:0x3
  v_mov_b32_dpp v32, v25 row_newbcast:14 row_mask:0xf bank_mask:0xc
  v_and_b32 v8, v32, v4
  v_and_b32 v9, v32, v5
  v_and_b32 v10, v32, v6
  v_and_b32 v11, v32, v7
  s_waitcnt vmcnt(7)
  buffer_load_dwordx4 v[200:203], v2, s[44:47], s12 offen offset:0 nt
  s_waitcnt vmcnt(7)
  buffer_load_dwordx4 v[204:207], v2, s[44:47], s12 offen offset:256 nt
  s_add_u32 s12, s12, 8192
  v_mfma_f32_16x16x32_bf16 v[16:19], v[168:171], v[8:11], v[16:19]
  v_mfma_f32_16x16x32_bf16 v[20:23], v[172:175], v[8:11], v[20:23]
  v_mov_b32_dpp v33, v25 row_newbcast:7 row_mask:0xf bank_mask:0x3
  v_mov_b32_dpp v33, v25 row_newbcast:15 row_mask:0xf bank_mask:0xc
  v_and_b32 v12, v33, v4
  v_and_b32 v13, v33, v5
  v_and_b32 v14, v33, v6
  v_and_b32 v15, v33, v7
  s_waitcnt vmcnt(7)
  buffer_load_dwordx4 v[208:211], v2, s[44:47], s12 offen offset:0 nt
  s_waitcnt vmcnt(7)
  buffer_load_dwordx4 v[212:215], v2, s[44:47], s12 offen offset:256 nt
  s_add_u32 s12, s12, 8192
  v_mfma_f32_16x16x32_bf16 v[16:19], v[176:179], v[12:15], v[16:19]
  v_mfma_f32_16x16x32_bf16 v[20:23], v[180:183], v[12:15], v[20:23]
  v_mov_b32_dpp v32, v26 row_newbcast:0 row_mask:0xf bank_mask:0x3
  v_mov_b32_dpp v32, v26 row_newbcast:8 row_mask:0xf bank_mask:0xc
  v_and_b32 v8, v32, v4
  v_and_b32 v9, v32, v5
  v_and_b32 v10, v32, v6
  v_and_b32 v11, v32, v7
  s_waitcnt vmcnt(7)
  buffer_load_dwordx4 v[216:219], v2, s[44:47], s12 offen offset:0 nt
  s_waitcnt vmcnt(7)
  buffer_load_dwordx4 v[220:223], v2, s[44:47], s12 offen offset:256 nt
  s_add_u32 s12, s12, 8192
  v_mfma_f32_16x16x32_bf16 v[16:19], v[184:187], v[8:11], v[16:19]
  v_mfma_f32_16x16x32_bf16 v[20:23], v[188:191], v[8:11], v[20:23]
  v_mov_b32_dpp v33, v26 row_newbcast:1 row_mask:0xf bank_mask:0x3
  v_mov_b32_dpp v33, v26 row_newbcast:9 row_mask:0xf bank_mask:0xc
  v_and_b32 v12, v33, v4
  v_and_b32 v13, v33, v5
  v_and_b32 v14, v33, v6
  v_and_b32 v15, v33, v7
  s_waitcnt vmcnt(7)
  buffer_load_dwordx4 v[224:227], v2, s[44:47], s12 offen offset:0 nt
  s_waitcnt vmcnt(7)
  buffer_load_dwordx4 v[228:231], v2, s[44:47], s12 offen offset:256 nt
  s_add_u32 s12, s12, 8192
  v_mfma_f32_16x16x32_bf16 v[16:19], v[192:195], v[12:15], v[16:19]
  v_mfma_f32_16x16x32_bf16 v[20:23], v[196:199], v[12:15], v[20:23]
  v_mov_b32_dpp v32, v26 row_newbcast:2 row_mask:0xf bank_mask:0x3
  v_mov_b32_dpp v32, v26 row_newbcast:10 row_mask:0xf bank_mask:0xc
  v_and_b32 v8, v32, v4
  v_and_b32 v9, v32, v5
  v_and_b32 v10, v32, v6
  v_and_b32 v11, v32, v7
  s_waitcnt vmcnt(7)
  buffer_load_dwordx4 v[232:235], v2, s[44:47], s12 offen offset:0 nt
  s_waitcnt vmcnt(7)
  buffer_load_dwordx4 v[236:239], v2, s[44:47], s12 offen offset:256 nt
  s_add_u32 s12, s12, 8192
  v_mfma_f32_16x16x32_bf16 v[16:19], v[200:203], v[8:11], v[16:19]
  v_mfma_f32_16x16x32_bf16 v[20:23], v[204:207], v[8:11], v[20:23]
  v_mov_b32_dpp v33, v26 row_newbcast:3 row_mask:0xf bank_mask:0x3
  v_mov_b32_dpp v33, v26 row_newbcast:11 row_mask:0xf bank_mask:0xc
  v_and_b32 v12, v33, v4
  v_and_b32 v13, v33, v5
  v_and_b32 v14, v33, v6
  v_and_b32 v15, v33, v7
  s_waitcnt vmcnt(7)
  buffer_load_dwordx4 v[240:243], v2, s[44:47], s12 offen offset:0 nt
  s_waitcnt vmcnt(7)
  buffer_load_dwordx4 v[244:247], v2, s[44:47], s12 offen offset:256 nt
  s_add_u32 s12, s12, 8192
  v_mfma_f32_16x16x32_bf16 v[16:19], v[208:211], v[12:15], v[16:19]
  v_mfma_f32_16x16x32_bf16 v[20:23], v[212:215], v[12:15], v[20:23]
  v_mov_b32_dpp v32, v26 row_newbcast:4 row_mask:0xf bank_mask:0x3
  v_mov_b32_dpp v32, v26 row_newbcast:12 row_mask:0xf bank_mask:0xc
  v_and_b32 v8, v32, v4
  v_and_b32 v9, v32, v5
  v_and_b32 v10, v32, v6
  v_and_b32 v11, v32, v7
  s_waitcnt vmcnt(7)
  buffer_load_dwordx4 v[248:251], v2, s[44:47], s12 offen offset:0 nt
  s_waitcnt vmcnt(7)
  buffer_load_dwordx4 v[252:255], v2, s[44:47], s12 offen offset:256 nt
  s_add_u32 s12, s12, 8192
  v_mfma_f32_16x16x32_bf16 v[16:19], v[216:219], v[8:11], v[16:19]
  v_mfma_f32_16x16x32_bf16 v[20:23], v[220:223], v[8:11], v[20:23]
  v_mov_b32_dpp v33, v26 row_newbcast:5 row_mask:0xf bank_mask:0x3
  v_mov_b32_dpp v33, v26 row_newbcast:13 row_mask:0xf bank_mask:0xc
  v_and_b32 v12, v33, v4
  v_and_b32 v13, v33, v5
  v_and_b32 v14, v33, v6
  v_and_b32 v15, v33, v7
  s_waitcnt vmcnt(7)
  buffer_load_dwordx4 v[56:59], v2, s[44:47], s12 offen offset:0 nt
  s_waitcnt vmcnt(7)
  buffer_load_dwordx4 v[60:63], v2, s[44:47], s12 offen offset:256 nt
  s_add_u32 s12, s12, 8192
  v_mfma_f32_16x16x32_bf16 v[16:19], v[224:227], v[12:15], v[16:19]
  v_mfma_f32_16x16x32_bf16 v[20:23], v[228:231], v[12:15], v[20:23]
  v_mov_b32_dpp v32, v26 row_newbcast:6 row_mask:0xf bank_mask:0x3
  v_mov_b32_dpp v32, v26 row_newbcast:14 row_mask:0xf bank_mask:0xc
  v_and_b32 v8, v32, v4
  v_and_b32 v9, v32, v5
  v_and_b32 v10, v32, v6
  v_and_b32 v11, v32, v7
  s_waitcnt vmcnt(7)
  buffer_load_dwordx4 v[64:67], v2, s[44:47], s12 offen offset:0 nt
  s_waitcnt vmcnt(7)
  buffer_load_dwordx4 v[68:71], v2, s[44:47], s12 offen offset:256 nt
  s_add_u32 s12, s12, 8192
  v_mfma_f32_16x16x32_bf16 v[16:19], v[232:235], v[8:11], v[16:19]
  v_mfma_f32_16x16x32_bf16 v[20:23], v[236:239], v[8:11], v[20:23]
  v_mov_b32_dpp v33, v26 row_newbcast:7 row_mask:0xf bank_mask:0x3
  v_mov_b32_dpp v33, v26 row_newbcast:15 row_mask:0xf bank_mask:0xc
  v_and_b32 v12, v33, v4
  v_and_b32 v13, v33, v5
  v_and_b32 v14, v33, v6
  v_and_b32 v15, v33, v7
  s_waitcnt vmcnt(7)
  buffer_load_dwordx4 v[72:75], v2, s[44:47], s12 offen offset:0 nt
  s_waitcnt vmcnt(7)
  buffer_load_dwordx4 v[76:79], v2, s[44:47], s12 offen offset:256 nt
  s_add_u32 s12, s12, 8192
  v_mfma_f32_16x16x32_bf16 v[16:19], v[240:243], v[12:15], v[16:19]
  v_mfma_f32_16x16x32_bf16 v[20:23], v[244:247], v[12:15], v[20:23]
  v_mov_b32_dpp v32, v27 row_newbcast:0 row_mask:0xf bank_mask:0x3
  v_mov_b32_dpp v32, v27 row_newbcast:8 row_mask:0xf bank_mask:0xc
  v_and_b32 v8, v32, v4
  v_and_b32 v9, v32, v5
  v_and_b32 v10, v32, v6
  v_and_b32 v11, v32, v7
  s_waitcnt vmcnt(7)
  buffer_load_dwordx4 v[80:83], v2, s[44:47], s12 offen offset:0 nt
  s_waitcnt vmcnt(7)
  buffer_load_dwordx4 v[84:87], v2, s[44:47], s12 offen offset:256 nt
  s_add_u32 s12, s12, 8192
  v_mfma_f32_16x16x32_bf16 v[16:19], v[248:251], v[8:11], v[16:19]
  v_mfma_f32_16x16x32_bf16 v[20:23], v[252:255], v[8:11], v[20:23]
  v_mov_b32_dpp v33, v27 row_newbcast:1 row_mask:0xf bank_mask:0x3
  v_mov_b32_dpp v33, v27 row_newbcast:9 row_mask:0xf bank_mask:0xc
  v_and_b32 v12, v33, v4
  v_and_b32 v13, v33, v5
  v_and_b32 v14, v33, v6
  v_and_b32 v15, v33, v7
  s_waitcnt vmcnt(7)
  buffer_load_dwordx4 v[88:91], v2, s[44:47], s12 offen offset:0 nt
  s_waitcnt vmcnt(7)
  buffer_load_dwordx4 v[92:95], v2, s[44:47], s12 offen offset:256 nt
  s_add_u32 s12, s12, 8192
  v_mfma_f32_16x16x32_bf16 v[16:19], v[56:59], v[12:15], v[16:19]
  v_mfma_f32_16x16x32_bf16 v[20:23], v[60:63], v[12:15], v[20:23]
  v_mov_b32_dpp v32, v27 row_newbcast:2 row_mask:0xf bank_mask:0x3
  v_mov_b32_dpp v32, v27 row_newbcast:10 row_mask:0xf bank_mask:0xc
  v_and_b32 v8, v32, v4
  v_and_b32 v9, v32, v5
  v_and_b32 v10, v32, v6
  v_and_b32 v11, v32, v7
  s_waitcnt vmcnt(7)
  buffer_load_dwordx4 v[96:99], v2, s[44:47], s12 offen offset:0 nt
  s_waitcnt vmcnt(7)
  buffer_load_dwordx4 v[100:103], v2, s[44:47], s12 offen offset:256 nt
  s_add_u32 s12, s12, 8192
  v_mfma_f32_16x16x32_bf16 v[16:19], v[64:67], v[8:11], v[16:19]
  v_mfma_f32_16x16x32_bf16 v[20:23], v[68:71], v[8:11], v[20:23]
  v_mov_b32_dpp v33, v27 row_newbcast:3 row_mask:0xf bank_mask:0x3
  v_mov_b32_dpp v33, v27 row_newbcast:11 row_mask:0xf bank_mask:0xc
  v_and_b32 v12, v33, v4
  v_and_b32 v13, v33, v5
  v_and_b32 v14, v33, v6
  v_and_b32 v15, v33, v7
  s_waitcnt vmcnt(7)
  buffer_load_dwordx4 v[104:107], v2, s[44:47], s12 offen offset:0 nt
  s_waitcnt vmcnt(7)
  buffer_load_dwordx4 v[108:111], v2, s[44:47], s12 offen offset:256 nt
  s_add_u32 s12, s12, 8192
  v_mfma_f32_16x16x32_bf16 v[16:19], v[72:75], v[12:15], v[16:19]
  v_mfma_f32_16x16x32_bf16 v[20:23], v[76:79], v[12:15], v[20:23]
  v_mov_b32_dpp v32, v27 row_newbcast:4 row_mask:0xf bank_mask:0x3
  v_mov_b32_dpp v32, v27 row_newbcast:12 row_mask:0xf bank_mask:0xc
  v_and_b32 v8, v32, v4
  v_and_b32 v9, v32, v5
  v_and_b32 v10, v32, v6
  v_and_b32 v11, v32, v7
  s_waitcnt vmcnt(7)
  buffer_load_dwordx4 v[112:115], v2, s[44:47], s12 offen offset:0 nt
  s_waitcnt vmcnt(7)
  buffer_load_dwordx4 v[116:119], v2, s[44:47], s12 offen offset:256 nt
  s_add_u32 s12, s12, 8192
  v_mfma_f32_16x16x32_bf16 v[16:19], v[80:83], v[8:11], v[16:19]
  v_mfma_f32_16x16x32_bf16 v[20:23], v[84:87], v[8:11], v[20:23]
  v_mov_b32_dpp v33, v27 row_newbcast:5 row_mask:0xf bank_mask:0x3
  v_mov_b32_dpp v33, v27 row_newbcast:13 row_mask:0xf bank_mask:0xc
  v_and_b32 v12, v33, v4
  v_and_b32 v13, v33, v5
  v_and_b32 v14, v33, v6
  v_and_b32 v15, v33, v7
  s_waitcnt vmcnt(7)
  buffer_load_dwordx4 v[120:123], v2, s[44:47], s12 offen offset:0 nt
  s_waitcnt vmcnt(7)
  buffer_load_dwordx4 v[124:127], v2, s[44:47], s12 offen offset:256 nt
  s_add_u32 s12, s12, 8192
  v_mfma_f32_16x16x32_bf16 v[16:19], v[88:91], v[12:15], v[16:19]
  v_mfma_f32_16x16x32_bf16 v[20:23], v[92:95], v[12:15], v[20:23]
  v_mov_b32_dpp v32, v27 row_newbcast:6 row_mask:0xf bank_mask:0x3
  v_mov_b32_dpp v32, v27 row_newbcast:14 row_mask:0xf bank_mask:0xc
  v_and_b32 v8, v32, v4
  v_and_b32 v9, v32, v5
  v_and_b32 v10, v32, v6
  v_and_b32 v11, v32, v7
  s_waitcnt vmcnt(7)
  buffer_load_dwordx4 v[128:131], v2, s[44:47], s12 offen offset:0 nt
  s_waitcnt vmcnt(7)
  buffer_load_dwordx4 v[132:135], v2, s[44:47], s12 offen offset:256 nt
  s_add_u32 s12, s12, 8192
  v_mfma_f32_16x16x32_bf16 v[16:19], v[96:99], v[8:11], v[16:19]
  v_mfma_f32_16x16x32_bf16 v[20:23], v[100:103], v[8:11], v[20:23]
  v_mov_b32_dpp v33, v27 row_newbcast:7 row_mask:0xf bank_mask:0x3
  v_mov_b32_dpp v33, v27 row_newbcast:15 row_mask:0xf bank_mask:0xc
  v_and_b32 v12, v33, v4
  v_and_b32 v13, v33, v5
  v_and_b32 v14, v33, v6
  v_and_b32 v15, v33, v7
  s_waitcnt vmcnt(7)
  buffer_load_dwordx4 v[136:139], v2, s[44:47], s12 offen offset:0 nt
  s_waitcnt vmcnt(7)
  buffer_load_dwordx4 v[140:143], v2, s[44:47], s12 offen offset:256 nt
  s_add_u32 s12, s12, 8192
  v_mfma_f32_16x16x32_bf16 v[16:19], v[104:107], v[12:15], v[16:19]
  v_mfma_f32_16x16x32_bf16 v[20:23], v[108:111], v[12:15], v[20:23]
  v_mov_b32_dpp v32, v28 row_newbcast:0 row_mask:0xf bank_mask:0x3
  v_mov_b32_dpp v32, v28 row_newbcast:8 row_mask:0xf bank_mask:0xc
  v_and_b32 v8, v32, v4
  v_and_b32 v9, v32, v5
  v_and_b32 v10, v32, v6
  v_and_b32 v11, v32, v7
  s_waitcnt vmcnt(7)
  buffer_load_dwordx4 v[144:147], v2, s[44:47], s12 offen offset:0 nt
  s_waitcnt vmcnt(7)
  buffer_load_dwordx4 v[148:151], v2, s[44:47], s12 offen offset:256 nt
  s_add_u32 s12, s12, 8192
  v_mfma_f32_16x16x32_bf16 v[16:19], v[112:115], v[8:11], v[16:19]
  v_mfma_f32_16x16x32_bf16 v[20:23], v[116:119], v[8:11], v[20:23]
  v_mov_b32_dpp v33, v28 row_newbcast:1 row_mask:0xf bank_mask:0x3
  v_mov_b32_dpp v33, v28 row_newbcast:9 row_mask:0xf bank_mask:0xc
  v_and_b32 v12, v33, v4
  v_and_b32 v13, v33, v5
  v_and_b32 v14, v33, v6
  v_and_b32 v15, v33, v7
  s_waitcnt vmcnt(7)
  buffer_load_dwordx4 v[152:155], v2, s[44:47], s12 offen offset:0 nt
  s_waitcnt vmcnt(7)
  buffer_load_dwordx4 v[156:159], v2, s[44:47], s12 offen offset:256 nt
  s_add_u32 s12, s12, 8192
  v_mfma_f32_16x16x32_bf16 v[16:19], v[120:123], v[12:15], v[16:19]
  v_mfma_f32_16x16x32_bf16 v[20:23], v[124:127], v[12:15], v[20:23]
  v_mov_b32_dpp v32, v28 row_newbcast:2 row_mask:0xf bank_mask:0x3
  v_mov_b32_dpp v32, v28 row_newbcast:10 row_mask:0xf bank_mask:0xc
  v_and_b32 v8, v32, v4
  v_and_b32 v9, v32, v5
  v_and_b32 v10, v32, v6
  v_and_b32 v11, v32, v7
  s_waitcnt vmcnt(7)
  buffer_load_dwordx4 v[160:163], v2, s[44:47], s12 offen offset:0 nt
  s_waitcnt vmcnt(7)
  buffer_load_dwordx4 v[164:167], v2, s[44:47], s12 offen offset:256 nt
  s_add_u32 s12, s12, 8192
  v_mfma_f32_16x16x32_bf16 v[16:19], v[128:131], v[8:11], v[16:19]
  v_mfma_f32_16x16x32_bf16 v[20:23], v[132:135], v[8:11], v[20:23]
  v_mov_b32_dpp v33, v28 row_newbcast:3 row_mask:0xf bank_mask:0x3
  v_mov_b32_dpp v33, v28 row_newbcast:11 row_mask:0xf bank_mask:0xc
  v_and_b32 v12, v33, v4
  v_and_b32 v13, v33, v5
  v_and_b32 v14, v33, v6
  v_and_b32 v15, v33, v7
  s_waitcnt vmcnt(7)
  buffer_load_dwordx4 v[168:171], v2, s[44:47], s12 offen offset:0 nt
  s_waitcnt vmcnt(7)
  buffer_load_dwordx4 v[172:175], v2, s[44:47], s12 offen offset:256 nt
  s_add_u32 s12, s12, 8192
  v_mfma_f32_16x16x32_bf16 v[16:19], v[136:139], v[12:15], v[16:19]
  v_mfma_f32_16x16x32_bf16 v[20:23], v[140:143], v[12:15], v[20:23]
  v_mov_b32_dpp v32, v28 row_newbcast:4 row_mask:0xf bank_mask:0x3
  v_mov_b32_dpp v32, v28 row_newbcast:12 row_mask:0xf bank_mask:0xc
  v_and_b32 v8, v32, v4
  v_and_b32 v9, v32, v5
  v_and_b32 v10, v32, v6
  v_and_b32 v11, v32, v7
  s_waitcnt vmcnt(7)
  buffer_load_dwordx4 v[176:179], v2, s[44:47], s12 offen offset:0 nt
  s_waitcnt vmcnt(7)
  buffer_load_dwordx4 v[180:183], v2, s[44:47], s12 offen offset:256 nt
  s_add_u32 s12, s12, 8192
  v_mfma_f32_16x16x32_bf16 v[16:19], v[144:147], v[8:11], v[16:19]
  v_mfma_f32_16x16x32_bf16 v[20:23], v[148:151], v[8:11], v[20:23]
  v_mov_b32_dpp v33, v28 row_newbcast:5 row_mask:0xf bank_mask:0x3
  v_mov_b32_dpp v33, v28 row_newbcast:13 row_mask:0xf bank_mask:0xc
  v_and_b32 v12, v33, v4
  v_and_b32 v13, v33, v5
  v_and_b32 v14, v33, v6
  v_and_b32 v15, v33, v7
  s_waitcnt vmcnt(7)
  buffer_load_dwordx4 v[184:187], v2, s[44:47], s12 offen offset:0 nt
  s_waitcnt vmcnt(7)
  buffer_load_dwordx4 v[188:191], v2, s[44:47], s12 offen offset:256 nt
  s_add_u32 s12, s12, 8192
  v_mfma_f32_16x16x32_bf16 v[16:19], v[152:155], v[12:15], v[16:19]
  v_mfma_f32_16x16x32_bf16 v[20:23], v[156:159], v[12:15], v[20:23]
  v_mov_b32_dpp v32, v28 row_newbcast:6 row_mask:0xf bank_mask:0x3
  v_mov_b32_dpp v32, v28 row_newbcast:14 row_mask:0xf bank_mask:0xc
  v_and_b32 v8, v32, v4
  v_and_b32 v9, v32, v5
  v_and_b32 v10, v32, v6
  v_and_b32 v11, v32, v7
  s_waitcnt vmcnt(7)
  buffer_load_dwordx4 v[192:195], v2, s[44:47], s12 offen offset:0 nt
  s_waitcnt vmcnt(7)
  buffer_load_dwordx4 v[196:199], v2, s[44:47], s12 offen offset:256 nt
  s_add_u32 s12, s12, 8192
  v_mfma_f32_16x16x32_bf16 v[16:19], v[160:163], v[8:11], v[16:19]
  v_mfma_f32_16x16x32_bf16 v[20:23], v[164:167], v[8:11], v[20:23]
  v_mov_b32_dpp v33, v28 row_newbcast:7 row_mask:0xf bank_mask:0x3
  v_mov_b32_dpp v33, v28 row_newbcast:15 row_mask:0xf bank_mask:0xc
  v_and_b32 v12, v33, v4
  v_and_b32 v13, v33, v5
  v_and_b32 v14, v33, v6
  v_and_b32 v15, v33, v7
  s_waitcnt vmcnt(7)
  buffer_load_dwordx4 v[200:203], v2, s[44:47], s12 offen offset:0 nt
  s_waitcnt vmcnt(7)
  buffer_load_dwordx4 v[204:207], v2, s[44:47], s12 offen offset:256 nt
  s_add_u32 s12, s12, 8192
  v_mfma_f32_16x16x32_bf16 v[16:19], v[168:171], v[12:15], v[16:19]
  v_mfma_f32_16x16x32_bf16 v[20:23], v[172:175], v[12:15], v[20:23]
  v_mov_b32_dpp v32, v29 row_newbcast:0 row_mask:0xf bank_mask:0x3
  v_mov_b32_dpp v32, v29 row_newbcast:8 row_mask:0xf bank_mask:0xc
  v_and_b32 v8, v32, v4
  v_and_b32 v9, v32, v5
  v_and_b32 v10, v32, v6
  v_and_b32 v11, v32, v7
  s_waitcnt vmcnt(7)
  buffer_load_dwordx4 v[208:211], v2, s[44:47], s12 offen offset:0 nt
  s_waitcnt vmcnt(7)
  buffer_load_dwordx4 v[212:215], v2, s[44:47], s12 offen offset:256 nt
  s_add_u32 s12, s12, 8192
  v_mfma_f32_16x16x32_bf16 v[16:19], v[176:179], v[8:11], v[16:19]
  v_mfma_f32_16x16x32_bf16 v[20:23], v[180:183], v[8:11], v[20:23]
  v_mov_b32_dpp v33, v29 row_newbcast:1 row_mask:0xf bank_mask:0x3
  v_mov_b32_dpp v33, v29 row_newbcast:9 row_mask:0xf bank_mask:0xc
  v_and_b32 v12, v33, v4
  v_and_b32 v13, v33, v5
  v_and_b32 v14, v33, v6
  v_and_b32 v15, v33, v7
  s_waitcnt vmcnt(7)
  buffer_load_dwordx4 v[216:219], v2, s[44:47], s12 offen offset:0 nt
  s_waitcnt vmcnt(7)
  buffer_load_dwordx4 v[220:223], v2, s[44:47], s12 offen offset:256 nt
  s_add_u32 s12, s12, 8192
  v_mfma_f32_16x16x32_bf16 v[16:19], v[184:187], v[12:15], v[16:19]
  v_mfma_f32_16x16x32_bf16 v[20:23], v[188:191], v[12:15], v[20:23]
  v_mov_b32_dpp v32, v29 row_newbcast:2 row_mask:0xf bank_mask:0x3
  v_mov_b32_dpp v32, v29 row_newbcast:10 row_mask:0xf bank_mask:0xc
  v_and_b32 v8, v32, v4
  v_and_b32 v9, v32, v5
  v_and_b32 v10, v32, v6
  v_and_b32 v11, v32, v7
  s_waitcnt vmcnt(7)
  buffer_load_dwordx4 v[224:227], v2, s[44:47], s12 offen offset:0 nt
  s_waitcnt vmcnt(7)
  buffer_load_dwordx4 v[228:231], v2, s[44:47], s12 offen offset:256 nt
  s_add_u32 s12, s12, 8192
  v_mfma_f32_16x16x32_bf16 v[16:19], v[192:195], v[8:11], v[16:19]
  v_mfma_f32_16x16x32_bf16 v[20:23], v[196:199], v[8:11], v[20:23]
  v_mov_b32_dpp v33, v29 row_newbcast:3 row_mask:0xf bank_mask:0x3
  v_mov_b32_dpp v33, v29 row_newbcast:11 row_mask:0xf bank_mask:0xc
  v_and_b32 v12, v33, v4
  v_and_b32 v13, v33, v5
  v_and_b32 v14, v33, v6
  v_and_b32 v15, v33, v7
  s_waitcnt vmcnt(7)
  buffer_load_dwordx4 v[232:235], v2, s[44:47], s12 offen offset:0 nt
  s_waitcnt vmcnt(7)
  buffer_load_dwordx4 v[236:239], v2, s[44:47], s12 offen offset:256 nt
  s_add_u32 s12, s12, 8192
  v_mfma_f32_16x16x32_bf16 v[16:19], v[200:203], v[12:15], v[16:19]
  v_mfma_f32_16x16x32_bf16 v[20:23], v[204:207], v[12:15], v[20:23]
  v_mov_b32_dpp v32, v29 row_newbcast:4 row_mask:0xf bank_mask:0x3
  v_mov_b32_dpp v32, v29 row_newbcast:12 row_mask:0xf bank_mask:0xc
  v_and_b32 v8, v32, v4
  v_and_b32 v9, v32, v5
  v_and_b32 v10, v32, v6
  v_and_b32 v11, v32, v7
  s_waitcnt vmcnt(7)
  buffer_load_dwordx4 v[240:243], v2, s[44:47], s12 offen offset:0 nt
  s_waitcnt vmcnt(7)
  buffer_load_dwordx4 v[244:247], v2, s[44:47], s12 offen offset:256 nt
  s_add_u32 s12, s12, 8192
  v_mfma_f32_16x16x32_bf16 v[16:19], v[208:211], v[8:11], v[16:19]
  v_mfma_f32_16x16x32_bf16 v[20:23], v[212:215], v[8:11], v[20:23]
  v_mov_b32_dpp v33, v29 row_newbcast:5 row_mask:0xf bank_mask:0x3
  v_mov_b32_dpp v33, v29 row_newbcast:13 row_mask:0xf bank_mask:0xc
  v_and_b32 v12, v33, v4
  v_and_b32 v13, v33, v5
  v_and_b32 v14, v33, v6
  v_and_b32 v15, v33, v7
  s_waitcnt vmcnt(7)
  buffer_load_dwordx4 v[248:251], v2, s[44:47], s12 offen offset:0 nt
  s_waitcnt vmcnt(7)
  buffer_load_dwordx4 v[252:255], v2, s[44:47], s12 offen offset:256 nt
  s_add_u32 s12, s12, 8192
  v_mfma_f32_16x16x32_bf16 v[16:19], v[216:219], v[12:15], v[16:19]
  v_mfma_f32_16x16x32_bf16 v[20:23], v[220:223], v[12:15], v[20:23]
  v_mov_b32_dpp v32, v29 row_newbcast:6 row_mask:0xf bank_mask:0x3
  v_mov_b32_dpp v32, v29 row_newbcast:14 row_mask:0xf bank_mask:0xc
  v_and_b32 v8, v32, v4
  v_and_b32 v9, v32, v5
  v_and_b32 v10, v32, v6
  v_and_b32 v11, v32, v7
  s_waitcnt vmcnt(7)
  buffer_load_dwordx4 v[56:59], v2, s[44:47], s12 offen offset:0 nt
  s_waitcnt vmcnt(7)
  buffer_load_dwordx4 v[60:63], v2, s[44:47], s12 offen offset:256 nt
  s_add_u32 s12, s12, 8192
  v_mfma_f32_16x16x32_bf16 v[16:19], v[224:227], v[8:11], v[16:19]
  v_mfma_f32_16x16x32_bf16 v[20:23], v[228:231], v[8:11], v[20:23]
  v_mov_b32_dpp v33, v29 row_newbcast:7 row_mask:0xf bank_mask:0x3
  v_mov_b32_dpp v33, v29 row_newbcast:15 row_mask:0xf bank_mask:0xc
  v_and_b32 v12, v33, v4
  v_and_b32 v13, v33, v5
  v_and_b32 v14, v33, v6
  v_and_b32 v15, v33, v7
  s_waitcnt vmcnt(7)
  buffer_load_dwordx4 v[64:67], v2, s[44:47], s12 offen offset:0 nt
  s_waitcnt vmcnt(7)
  buffer_load_dwordx4 v[68:71], v2, s[44:47], s12 offen offset:256 nt
  s_add_u32 s12, s12, 8192
  v_mfma_f32_16x16x32_bf16 v[16:19], v[232:235], v[12:15], v[16:19]
  v_mfma_f32_16x16x32_bf16 v[20:23], v[236:239], v[12:15], v[20:23]
  v_mov_b32_dpp v32, v30 row_newbcast:0 row_mask:0xf bank_mask:0x3
  v_mov_b32_dpp v32, v30 row_newbcast:8 row_mask:0xf bank_mask:0xc
  v_and_b32 v8, v32, v4
  v_and_b32 v9, v32, v5
  v_and_b32 v10, v32, v6
  v_and_b32 v11, v32, v7
  s_waitcnt vmcnt(7)
  buffer_load_dwordx4 v[72:75], v2, s[44:47], s12 offen offset:0 nt
  s_waitcnt vmcnt(7)
  buffer_load_dwordx4 v[76:79], v2, s[44:47], s12 offen offset:256 nt
  s_add_u32 s12, s12, 8192
  v_mfma_f32_16x16x32_bf16 v[16:19], v[240:243], v[8:11], v[16:19]
  v_mfma_f32_16x16x32_bf16 v[20:23], v[244:247], v[8:11], v[20:23]
  v_mov_b32_dpp v33, v30 row_newbcast:1 row_mask:0xf bank_mask:0x3
  v_mov_b32_dpp v33, v30 row_newbcast:9 row_mask:0xf bank_mask:0xc
  v_and_b32 v12, v33, v4
  v_and_b32 v13, v33, v5
  v_and_b32 v14, v33, v6
  v_and_b32 v15, v33, v7
  s_waitcnt vmcnt(7)
  buffer_load_dwordx4 v[80:83], v2, s[44:47], s12 offen offset:0 nt
  s_waitcnt vmcnt(7)
  buffer_load_dwordx4 v[84:87], v2, s[44:47], s12 offen offset:256 nt
  s_add_u32 s12, s12, 8192
  v_mfma_f32_16x16x32_bf16 v[16:19], v[248:251], v[12:15], v[16:19]
  v_mfma_f32_16x16x32_bf16 v[20:23], v[252:255], v[12:15], v[20:23]
  v_mov_b32_dpp v32, v30 row_newbcast:2 row_mask:0xf bank_mask:0x3
  v_mov_b32_dpp v32, v30 row_newbcast:10 row_mask:0xf bank_mask:0xc
  v_and_b32 v8, v32, v4
  v_and_b32 v9, v32, v5
  v_and_b32 v10, v32, v6
  v_and_b32 v11, v32, v7
  s_waitcnt vmcnt(7)
  buffer_load_dwordx4 v[88:91], v2, s[44:47], s12 offen offset:0 nt
  s_waitcnt vmcnt(7)
  buffer_load_dwordx4 v[92:95], v2, s[44:47], s12 offen offset:256 nt
  s_add_u32 s12, s12, 8192
  v_mfma_f32_16x16x32_bf16 v[16:19], v[56:59], v[8:11], v[16:19]
  v_mfma_f32_16x16x32_bf16 v[20:23], v[60:63], v[8:11], v[20:23]
  v_mov_b32_dpp v33, v30 row_newbcast:3 row_mask:0xf bank_mask:0x3
  v_mov_b32_dpp v33, v30 row_newbcast:11 row_mask:0xf bank_mask:0xc
  v_and_b32 v12, v33, v4
  v_and_b32 v13, v33, v5
  v_and_b32 v14, v33, v6
  v_and_b32 v15, v33, v7
  s_waitcnt vmcnt(7)
  buffer_load_dwordx4 v[96:99], v2, s[44:47], s12 offen offset:0 nt
  s_waitcnt vmcnt(7)
  buffer_load_dwordx4 v[100:103], v2, s[44:47], s12 offen offset:256 nt
  s_add_u32 s12, s12, 8192
  v_mfma_f32_16x16x32_bf16 v[16:19], v[64:67], v[12:15], v[16:19]
  v_mfma_f32_16x16x32_bf16 v[20:23], v[68:71], v[12:15], v[20:23]
  v_mov_b32_dpp v32, v30 row_newbcast:4 row_mask:0xf bank_mask:0x3
  v_mov_b32_dpp v32, v30 row_newbcast:12 row_mask:0xf bank_mask:0xc
  v_and_b32 v8, v32, v4
  v_and_b32 v9, v32, v5
  v_and_b32 v10, v32, v6
  v_and_b32 v11, v32, v7
  s_waitcnt vmcnt(7)
  buffer_load_dwordx4 v[104:107], v2, s[44:47], s12 offen offset:0 nt
  s_waitcnt vmcnt(7)
  buffer_load_dwordx4 v[108:111], v2, s[44:47], s12 offen offset:256 nt
  s_add_u32 s12, s12, 8192
  v_mfma_f32_16x16x32_bf16 v[16:19], v[72:75], v[8:11], v[16:19]
  v_mfma_f32_16x16x32_bf16 v[20:23], v[76:79], v[8:11], v[20:23]
  v_mov_b32_dpp v33, v30 row_newbcast:5 row_mask:0xf bank_mask:0x3
  v_mov_b32_dpp v33, v30 row_newbcast:13 row_mask:0xf bank_mask:0xc
  v_and_b32 v12, v33, v4
  v_and_b32 v13, v33, v5
  v_and_b32 v14, v33, v6
  v_and_b32 v15, v33, v7
  s_waitcnt vmcnt(7)
  buffer_load_dwordx4 v[112:115], v2, s[44:47], s12 offen offset:0 nt
  s_waitcnt vmcnt(7)
  buffer_load_dwordx4 v[116:119], v2, s[44:47], s12 offen offset:256 nt
  s_add_u32 s12, s12, 8192
  v_mfma_f32_16x16x32_bf16 v[16:19], v[80:83], v[12:15], v[16:19]
  v_mfma_f32_16x16x32_bf16 v[20:23], v[84:87], v[12:15], v[20:23]
  v_mov_b32_dpp v32, v30 row_newbcast:6 row_mask:0xf bank_mask:0x3
  v_mov_b32_dpp v32, v30 row_newbcast:14 row_mask:0xf bank_mask:0xc
  v_and_b32 v8, v32, v4
  v_and_b32 v9, v32, v5
  v_and_b32 v10, v32, v6
  v_and_b32 v11, v32, v7
  s_waitcnt vmcnt(7)
  buffer_load_dwordx4 v[120:123], v2, s[44:47], s12 offen offset:0 nt
  s_waitcnt vmcnt(7)
  buffer_load_dwordx4 v[124:127], v2, s[44:47], s12 offen offset:256 nt
  s_add_u32 s12, s12, 8192
  v_mfma_f32_16x16x32_bf16 v[16:19], v[88:91], v[8:11], v[16:19]
  v_mfma_f32_16x16x32_bf16 v[20:23], v[92:95], v[8:11], v[20:23]
  v_mov_b32_dpp v33, v30 row_newbcast:7 row_mask:0xf bank_mask:0x3
  v_mov_b32_dpp v33, v30 row_newbcast:15 row_mask:0xf bank_mask:0xc
  v_and_b32 v12, v33, v4
  v_and_b32 v13, v33, v5
  v_and_b32 v14, v33, v6
  v_and_b32 v15, v33, v7
  s_waitcnt vmcnt(7)
  buffer_load_dwordx4 v[128:131], v2, s[44:47], s12 offen offset:0 nt
  s_waitcnt vmcnt(7)
  buffer_load_dwordx4 v[132:135], v2, s[44:47], s12 offen offset:256 nt
  s_add_u32 s12, s12, 8192
  v_mfma_f32_16x16x32_bf16 v[16:19], v[96:99], v[12:15], v[16:19]
  v_mfma_f32_16x16x32_bf16 v[20:23], v[100:103], v[12:15], v[20:23]
  v_mov_b32_dpp v32, v31 row_newbcast:0 row_mask:0xf bank_mask:0x3
  v_mov_b32_dpp v32, v31 row_newbcast:8 row_mask:0xf bank_mask:0xc
  v_and_b32 v8, v32, v4
  v_and_b32 v9, v32, v5
  v_and_b32 v10, v32, v6
  v_and_b32 v11, v32, v7
  s_waitcnt vmcnt(7)
  buffer_load_dwordx4 v[136:139], v2, s[44:47], s12 offen offset:0 nt
  s_waitcnt vmcnt(7)
  buffer_load_dwordx4 v[140:143], v2, s[44:47], s12 offen offset:256 nt
  s_add_u32 s12, s12, 8192
  v_mfma_f32_16x16x32_bf16 v[16:19], v[104:107], v[8:11], v[16:19]
  v_mfma_f32_16x16x32_bf16 v[20:23], v[108:111], v[8:11], v[20:23]
  v_mov_b32_dpp v33, v31 row_newbcast:1 row_mask:0xf bank_mask:0x3
  v_mov_b32_dpp v33, v31 row_newbcast:9 row_mask:0xf bank_mask:0xc
  v_and_b32 v12, v33, v4
  v_and_b32 v13, v33, v5
  v_and_b32 v14, v33, v6
  v_and_b32 v15, v33, v7
  s_mul_i32 s13, s4, 17408
  s_lshl_b32 s15, s5, 2
  s_add_u32 s13, s13, s15
  s_add_u32 s13, s13, 5029888
  v_mul_u32_u24 v1, 4352, v0
  s_lshl_b32 s70, 1, s3
  s_mov_b32 s71, 0
  v_mov_b32 v36, s56
  s_mov_b64 exec, s[70:71]
  buffer_store_dword v36, v1, s[48:51], s13 offen sc1
  s_mov_b64 exec, -1
  s_waitcnt vmcnt(8)
  buffer_load_dwordx4 v[144:147], v2, s[44:47], s12 offen offset:0 nt
  s_waitcnt vmcnt(8)
  buffer_load_dwordx4 v[148:151], v2, s[44:47], s12 offen offset:256 nt
  s_add_u32 s12, s12, 8192
  v_mfma_f32_16x16x32_bf16 v[16:19], v[112:115], v[12:15], v[16:19]
  v_mfma_f32_16x16x32_bf16 v[20:23], v[116:119], v[12:15], v[20:23]
  v_mov_b32_dpp v32, v31 row_newbcast:2 row_mask:0xf bank_mask:0x3
  v_mov_b32_dpp v32, v31 row_newbcast:10 row_mask:0xf bank_mask:0xc
  v_and_b32 v8, v32, v4
  v_and_b32 v9, v32, v5
  v_and_b32 v10, v32, v6
  v_and_b32 v11, v32, v7
  s_waitcnt vmcnt(8)
  buffer_load_dwordx4 v[152:155], v2, s[44:47], s12 offen offset:0 nt
  s_waitcnt vmcnt(8)
  buffer_load_dwordx4 v[156:159], v2, s[44:47], s12 offen offset:256 nt
  s_add_u32 s12, s12, 8192
  v_mfma_f32_16x16x32_bf16 v[16:19], v[120:123], v[8:11], v[16:19]
  v_mfma_f32_16x16x32_bf16 v[20:23], v[124:127], v[8:11], v[20:23]
  v_mov_b32_dpp v33, v31 row_newbcast:3 row_mask:0xf bank_mask:0x3
  v_mov_b32_dpp v33, v31 row_newbcast:11 row_mask:0xf bank_mask:0xc
  v_and_b32 v12, v33, v4
  v_and_b32 v13, v33, v5
  v_and_b32 v14, v33, v6
  v_and_b32 v15, v33, v7
  s_waitcnt vmcnt(8)
  buffer_load_dwordx4 v[160:163], v2, s[44:47], s12 offen offset:0 nt
  s_waitcnt vmcnt(8)
  buffer_load_dwordx4 v[164:167], v2, s[44:47], s12 offen offset:256 nt
  s_add_u32 s12, s12, 8192
  v_mfma_f32_16x16x32_bf16 v[16:19], v[128:131], v[12:15], v[16:19]
  v_mfma_f32_16x16x32_bf16 v[20:23], v[132:135], v[12:15], v[20:23]
  v_mov_b32_dpp v32, v31 row_newbcast:4 row_mask:0xf bank_mask:0x3
  v_mov_b32_dpp v32, v31 row_newbcast:12 row_mask:0xf bank_mask:0xc
  v_and_b32 v8, v32, v4
  v_and_b32 v9, v32, v5
  v_and_b32 v10, v32, v6
  v_and_b32 v11, v32, v7
  s_waitcnt vmcnt(7)
  s_nop 0
  v_mfma_f32_16x16x32_bf16 v[16:19], v[136:139], v[8:11], v[16:19]
  v_mfma_f32_16x16x32_bf16 v[20:23], v[140:143], v[8:11], v[20:23]
  v_mov_b32_dpp v33, v31 row_newbcast:5 row_mask:0xf bank_mask:0x3
  v_mov_b32_dpp v33, v31 row_newbcast:13 row_mask:0xf bank_mask:0xc
  v_and_b32 v12, v33, v4
  v_and_b32 v13, v33, v5
  v_and_b32 v14, v33, v6
  v_and_b32 v15, v33, v7
  s_waitcnt vmcnt(4)
  s_nop 0
  v_mfma_f32_16x16x32_bf16 v[16:19], v[144:147], v[12:15], v[16:19]
  v_mfma_f32_16x16x32_bf16 v[20:23], v[148:151], v[12:15], v[20:23]
  v_mov_b32_dpp v32, v31 row_newbcast:6 row_mask:0xf bank_mask:0x3
  v_mov_b32_dpp v32, v31 row_newbcast:14 row_mask:0xf bank_mask:0xc
  v_and_b32 v8, v32, v4
  v_and_b32 v9, v32, v5
  v_and_b32 v10, v32, v6
  v_and_b32 v11, v32, v7
  s_waitcnt vmcnt(2)
  s_nop 0
  v_mfma_f32_16x16x32_bf16 v[16:19], v[152:155], v[8:11], v[16:19]
  v_mfma_f32_16x16x32_bf16 v[20:23], v[156:159], v[8:11], v[20:23]
  v_mov_b32_dpp v33, v31 row_newbcast:7 row_mask:0xf bank_mask:0x3
  v_mov_b32_dpp v33, v31 row_newbcast:15 row_mask:0xf bank_mask:0xc
  v_and_b32 v12, v33, v4
  v_and_b32 v13, v33, v5
  v_and_b32 v14, v33, v6
  v_and_b32 v15, v33, v7
  s_waitcnt vmcnt(0)
  s_nop 0
  v_mfma_f32_16x16x32_bf16 v[16:19], v[160:163], v[12:15], v[16:19]
  v_mfma_f32_16x16x32_bf16 v[20:23], v[164:167], v[12:15], v[20:23]
  s_nop 6
  ds_write_b128 v3, v[16:19]
  ds_write_b128 v3, v[20:23] offset:1024
  s_branch L_bar2
L_helper:
  s_setprio 3
  s_sub_u32 s15, s3, 4
  v_lshrrev_b32 v3, 4, v0
  v_bfe_u32 v4, v0, 2, 2
  v_and_b32 v5, 3, v0
  v_and_b32 v6, 15, v0
  v_mov_b32 v2, 160864
  v_lshlrev_b32 v7, 4, v0
  v_mov_b32 v12, 0
  s_waitcnt lgkmcnt(0)
  s_load_dwordx2 s[38:39], s[36:37], 0
  s_mov_b32 s54, 6291200
  s_load_dwordx2 s[52:53], s[36:37], s54
  s_mov_b32 s48, s36
  s_and_b32 s49, s37, 0xffff
  s_mov_b32 s50, 6291456
  s_mov_b32 s51, 0x20000
  s_cmp_lg_u32 s3, 4
  s_cbranch_scc1 L_h123
  s_cmp_ge_u32 s5, 23
  s_cbranch_scc1 L_h0late
  s_cmp_ge_u32 s5, 16
  s_cbranch_scc1 L_f1
  s_lshr_b32 s82, s5, 1
  s_and_b32 s83, s5, 1
  s_mov_b32 s40, s22
  s_and_b32 s41, s23, 0xffff
  s_mov_b32 s42, 3670016
  s_mov_b32 s43, 0x20000
  s_mov_b32 s10, 8192
  s_mul_i32 s11, s83, 1835008
  s_lshl_b32 s12, s4, 10
  s_add_u32 s11, s11, s12
  s_lshl_b32 s12, s82, 7
  s_add_u32 s11, s11, s12
  s_lshl_b32 s13, s83, 17
  s_lshl_b32 s12, s4, 11
  s_add_u32 s13, s13, s12
  s_lshl_b32 s12, s82, 8
  s_add_u32 s13, s13, s12
  s_add_u32 s13, s13, 4096
  s_mov_b32 s14, 16384
  s_mul_i32 s75, s4, 4352
  s_lshl_b32 s12, s5, 3
  s_add_u32 s75, s75, s12
  s_add_u32 s75, s75, 4194304
  v_mul_u32_u24 v13, 34816, v0
  s_mov_b32 s66, 0xff
  s_nop 0
  s_branch L_gemv
L_f1:
  s_mul_i32 s82, s4, 7
  s_add_u32 s82, s82, s5
  s_sub_u32 s82, s82, 16
  s_and_b32 s83, s82, 1
  s_lshr_b32 s82, s82, 1
  s_mov_b32 s40, s28
  s_and_b32 s41, s29, 0xffff
  s_mov_b32 s42, 1605632
  s_mov_b32 s43, 0x20000
  s_mov_b32 s10, 3584
  s_mul_i32 s11, s83, 802816
  s_lshl_b32 s12, s82, 7
  s_add_u32 s11, s11, s12
  s_mul_i32 s13, s83, 57344
  s_lshl_b32 s12, s82, 8
  s_add_u32 s13, s13, s12
  s_add_u32 s13, s13, 327680
  s_mov_b32 s14, 7168
  s_lshl_b32 s12, s82, 1
  v_add_u32 v13, s12, v0
  v_mul_u32_u24 v13, 9363, v13
  v_lshrrev_b32 v13, 16, v13
  v_mul_u32_u24 v14, 7, v13
  v_lshrrev_b32 v14, 1, v14
  v_sub_u32 v14, s82, v14
  v_lshlrev_b32 v14, 4, v14
  v_mul_u32_u24 v13, 4352, v13
  v_add_u32 v13, v13, v14
  s_lshl_b32 s75, s83, 3
  s_add_u32 s75, s75, 4472832
  s_mov_b32 s66, 3
L_gemv:
  s_mov_b32 s44, s16
  s_and_b32 s45, s17, 0xffff
  s_mov_b32 s46, 7168
  s_mov_b32 s47, 0x20000
  v_and_b32 v14, 7, v0
  v_mul_u32_u24 v14, 896, v14
  v_lshl_add_u32 v14, v3, 4, v14
  s_mul_i32 s72, s83, 448
  s_sub_u32 s73, 448, s72
  s_mov_b32 s70, 16711935
  s_mov_b32 s71, 16711935
  s_mov_b64 exec, s[70:71]
  buffer_load_dwordx4 v[64:67], v14, s[44:47], s72 offen offset:0
  buffer_load_dwordx4 v[68:71], v14, s[44:47], s72 offen offset:64
  buffer_load_dwordx4 v[72:75], v14, s[44:47], s72 offen offset:128
  buffer_load_dwordx4 v[76:79], v14, s[44:47], s72 offen offset:192
  buffer_load_dwordx4 v[80:83], v14, s[44:47], s72 offen offset:256
  buffer_load_dwordx4 v[84:87], v14, s[44:47], s72 offen offset:320
  buffer_load_dwordx4 v[88:91], v14, s[44:47], s72 offen offset:384
  buffer_load_dwordx4 v[92:95], v14, s[44:47], s73 offen offset:0
  buffer_load_dwordx4 v[96:99], v14, s[44:47], s73 offen offset:64
  buffer_load_dwordx4 v[100:103], v14, s[44:47], s73 offen offset:128
  buffer_load_dwordx4 v[104:107], v14, s[44:47], s73 offen offset:192
  buffer_load_dwordx4 v[108:111], v14, s[44:47], s73 offen offset:256
  buffer_load_dwordx4 v[112:115], v14, s[44:47], s73 offen offset:320
  buffer_load_dwordx4 v[116:119], v14, s[44:47], s73 offen offset:384
  s_mov_b64 exec, -1
  v_lshrrev_b32 v8, 3, v0
  v_mul_lo_u32 v8, v8, s10
  v_and_b32 v9, 7, v0
  v_lshl_add_u32 v8, v9, 4, v8
  s_lshl_b32 s72, s10, 3
  s_mov_b32 m0, 114688
  s_nop 0
  buffer_load_dwordx4 v8, s[40:43], s11 offen nt lds
  s_add_u32 s11, s11, s72
  s_mov_b32 m0, 115712
  s_nop 0
  buffer_load_dwordx4 v8, s[40:43], s11 offen nt lds
  s_add_u32 s11, s11, s72
  s_mov_b32 m0, 116736
  s_nop 0
  buffer_load_dwordx4 v8, s[40:43], s11 offen nt lds
  s_add_u32 s11, s11, s72
  s_mov_b32 m0, 117760
  s_nop 0
  buffer_load_dwordx4 v8, s[40:43], s11 offen nt lds
  s_add_u32 s11, s11, s72
  s_mov_b32 m0, 118784
  s_nop 0
  buffer_load_dwordx4 v8, s[40:43], s11 offen nt lds
  s_add_u32 s11, s11, s72
  s_mov_b32 m0, 119808
  s_nop 0
  buffer_load_dwordx4 v8, s[40:43], s11 offen nt lds
  s_add_u32 s11, s11, s72
  s_mov_b32 m0, 120832
  s_nop 0
  buffer_load_dwordx4 v8, s[40:43], s11 offen nt lds
  s_add_u32 s11, s11, s72
  s_mov_b32 m0, 121856
  s_nop 0
  buffer_load_dwordx4 v8, s[40:43], s11 offen nt lds
  s_add_u32 s11, s11, s72
  s_mov_b32 m0, 122880
  s_nop 0
  buffer_load_dwordx4 v8, s[40:43], s11 offen nt lds
  s_add_u32 s11, s11, s72
  s_mov_b32 m0, 123904
  s_nop 0
  buffer_load_dwordx4 v8, s[40:43], s11 offen nt lds
  s_add_u32 s11, s11, s72
  s_mov_b32 m0, 124928
  s_nop 0
  buffer_load_dwordx4 v8, s[40:43], s11 offen nt lds
  s_add_u32 s11, s11, s72
  s_mov_b32 m0, 125952
  s_nop 0
  buffer_load_dwordx4 v8, s[40:43], s11 offen nt lds
  s_add_u32 s11, s11, s72
  s_mov_b32 m0, 126976
  s_nop 0
  buffer_load_dwordx4 v8, s[40:43], s11 offen nt lds
  s_add_u32 s11, s11, s72
  s_mov_b32 m0, 128000
  s_nop 0
  buffer_load_dwordx4 v8, s[40:43], s11 offen nt lds
  s_add_u32 s11, s11, s72
  s_mov_b32 m0, 129024
  s_nop 0
  buffer_load_dwordx4 v8, s[40:43], s11 offen nt lds
  s_add_u32 s11, s11, s72
  s_mov_b32 m0, 130048
  s_nop 0
  buffer_load_dwordx4 v8, s[40:43], s11 offen nt lds
  s_add_u32 s11, s11, s72
  s_mov_b32 m0, 131072
  s_nop 0
  buffer_load_dwordx4 v8, s[40:43], s11 offen nt lds
  s_add_u32 s11, s11, s72
  s_mov_b32 m0, 132096
  s_nop 0
  buffer_load_dwordx4 v8, s[40:43], s11 offen nt lds
  s_add_u32 s11, s11, s72
  s_mov_b32 m0, 133120
  s_nop 0
  buffer_load_dwordx4 v8, s[40:43], s11 offen nt lds
  s_add_u32 s11, s11, s72
  s_mov_b32 m0, 134144
  s_nop 0
  buffer_load_dwordx4 v8, s[40:43], s11 offen nt lds
  s_add_u32 s11, s11, s72
  s_mov_b32 m0, 135168
  s_nop 0
  buffer_load_dwordx4 v8, s[40:43], s11 offen nt lds
  s_add_u32 s11, s11, s72
  s_mov_b32 m0, 136192
  s_nop 0
  buffer_load_dwordx4 v8, s[40:43], s11 offen nt lds
  s_add_u32 s11, s11, s72
  s_mov_b32 m0, 137216
  s_nop 0
  buffer_load_dwordx4 v8, s[40:43], s11 offen nt lds
  s_add_u32 s11, s11, s72
  s_mov_b32 m0, 138240
  s_nop 0
  buffer_load_dwordx4 v8, s[40:43], s11 offen nt lds
  s_add_u32 s11, s11, s72
  s_mov_b32 m0, 139264
  s_nop 0
  buffer_load_dwordx4 v8, s[40:43], s11 offen nt lds
  s_add_u32 s11, s11, s72
  s_mov_b32 m0, 140288
  s_nop 0
  buffer_load_dwordx4 v8, s[40:43], s11 offen nt lds
  s_add_u32 s11, s11, s72
  s_mov_b32 m0, 141312
  s_nop 0
  buffer_load_dwordx4 v8, s[40:43], s11 offen nt lds
  s_add_u32 s11, s11, s72
  s_mov_b32 m0, 142336
  s_nop 0
  buffer_load_dwordx4 v8, s[40:43], s11 offen nt lds
  s_add_u32 s11, s11, s72
  v_lshl_add_u32 v9, v3, 3, v4
  v_lshlrev_b32 v9, 7, v9
  v_lshl_add_u32 v9, v5, 3, v9
  v_add_u32 v9, 114688, v9
  v_and_b32 v10, 7, v0
  v_mul_lo_u32 v10, v10, s14
  v_bfe_u32 v11, v0, 3, 1
  v_lshl_add_u32 v10, v11, 6, v10
  v_lshl_add_u32 v10, v3, 4, v10
  v_add_u32 v10, s13, v10
  s_not_b64 exec, s[70:71]
  v_mov_b32 v64, 0x3f803f80
  v_mov_b32 v65, 0x3f803f80
  v_mov_b32 v66, 0x3f803f80
  v_mov_b32 v67, 0x3f803f80
  v_mov_b32 v68, 0x3f803f80
  v_mov_b32 v69, 0x3f803f80
  v_mov_b32 v70, 0x3f803f80
  v_mov_b32 v71, 0x3f803f80
  v_mov_b32 v72, 0x3f803f80
  v_mov_b32 v73, 0x3f803f80
  v_mov_b32 v74, 0x3f803f80
  v_mov_b32 v75, 0x3f803f80
  v_mov_b32 v76, 0x3f803f80
  v_mov_b32 v77, 0x3f803f80
  v_mov_b32 v78, 0x3f803f80
  v_mov_b32 v79, 0x3f803f80
  v_mov_b32 v80, 0x3f803f80
  v_mov_b32 v81, 0x3f803f80
  v_mov_b32 v82, 0x3f803f80
  v_mov_b32 v83, 0x3f803f80
  v_mov_b32 v84, 0x3f803f80
  v_mov_b32 v85, 0x3f803f80
  v_mov_b32 v86, 0x3f803f80
  v_mov_b32 v87, 0x3f803f80
  v_mov_b32 v88, 0x3f803f80
  v_mov_b32 v89, 0x3f803f80
  v_mov_b32 v90, 0x3f803f80
  v_mov_b32 v91, 0x3f803f80
  v_mov_b32 v92, 0x3f803f80
  v_mov_b32 v93, 0x3f803f80
  v_mov_b32 v94, 0x3f803f80
  v_mov_b32 v95, 0x3f803f80
  v_mov_b32 v96, 0x3f803f80
  v_mov_b32 v97, 0x3f803f80
  v_mov_b32 v98, 0x3f803f80
  v_mov_b32 v99, 0x3f803f80
  v_mov_b32 v100, 0x3f803f80
  v_mov_b32 v101, 0x3f803f80
  v_mov_b32 v102, 0x3f803f80
  v_mov_b32 v103, 0x3f803f80
  v_mov_b32 v104, 0x3f803f80
  v_mov_b32 v105, 0x3f803f80
  v_mov_b32 v106, 0x3f803f80
  v_mov_b32 v107, 0x3f803f80
  v_mov_b32 v108, 0x3f803f80
  v_mov_b32 v109, 0x3f803f80
  v_mov_b32 v110, 0x3f803f80
  v_mov_b32 v111, 0x3f803f80
  v_mov_b32 v112, 0x3f803f80
  v_mov_b32 v113, 0x3f803f80
  v_mov_b32 v114, 0x3f803f80
  v_mov_b32 v115, 0x3f803f80
  v_mov_b32 v116, 0x3f803f80
  v_mov_b32 v117, 0x3f803f80
  v_mov_b32 v118, 0x3f803f80
  v_mov_b32 v119, 0x3f803f80
  s_mov_b64 exec, -1
  v_and_b32 v22, 7, v0
  v_lshlrev_b32 v20, 2, v22
  v_lshrrev_b32 v21, 2, v22
  v_lshl_add_u32 v21, v21, 6, v20
  v_add_u32 v20, 128, v20
  s_mov_b32 s60, 572662306
  s_mov_b32 s61, 572662306
  s_mov_b32 s62, 1145324612
  s_mov_b32 s63, 1145324612
  s_mov_b32 s64, 2290649224
  s_mov_b32 s65, 2290649224
  s_waitcnt lgkmcnt(0)
  s_lshl_b32 s56, s52, 1
  s_sub_u32 s56, s56, s38
  s_add_u32 s56, s56, 1
  s_lshl_b32 s58, s53, 1
  s_sub_u32 s58, s58, s39
  s_add_u32 s58, s58, 1
  s_and_b32 s57, s58, 0xff
  s_mov_b32 s59, 0xffffff00
  s_barrier
  s_waitcnt vmcnt(28)
  v_mfma_f32_16x16x32_bf16 v[16:19], v[64:67], v[64:67], 0
  v_mfma_f32_16x16x32_bf16 v[16:19], v[68:71], v[68:71], v[16:19]
  v_mfma_f32_16x16x32_bf16 v[16:19], v[72:75], v[72:75], v[16:19]
  v_mfma_f32_16x16x32_bf16 v[16:19], v[76:79], v[76:79], v[16:19]
  v_mfma_f32_16x16x32_bf16 v[16:19], v[80:83], v[80:83], v[16:19]
  v_mfma_f32_16x16x32_bf16 v[16:19], v[84:87], v[84:87], v[16:19]
  v_mfma_f32_16x16x32_bf16 v[16:19], v[88:91], v[88:91], v[16:19]
  v_mfma_f32_16x16x32_bf16 v[16:19], v[92:95], v[92:95], v[16:19]
  v_mfma_f32_16x16x32_bf16 v[16:19], v[96:99], v[96:99], v[16:19]
  v_mfma_f32_16x16x32_bf16 v[16:19], v[100:103], v[100:103], v[16:19]
  v_mfma_f32_16x16x32_bf16 v[16:19], v[104:107], v[104:107], v[16:19]
  v_mfma_f32_16x16x32_bf16 v[16:19], v[108:111], v[108:111], v[16:19]
  v_mfma_f32_16x16x32_bf16 v[16:19], v[112:115], v[112:115], v[16:19]
  v_mfma_f32_16x16x32_bf16 v[16:19], v[116:119], v[116:119], v[16:19]
  s_nop 7
  v_cndmask_b32 v22, v16, v17, s[60:61]
  v_cndmask_b32 v22, v22, v18, s[62:63]
  v_cndmask_b32 v22, v22, v19, s[64:65]
  ds_bpermute_b32 v24, v20, v16
  ds_bpermute_b32 v25, v21, v22
  s_mov_b32 s72, 0x3b124925
  s_mov_b32 s73, 0x3727c5ac
  s_waitcnt lgkmcnt(0)
  s_waitcnt vmcnt(24)
  ds_read_b64_tr_b16 v[128:129], v9 offset:0
  ds_read_b64_tr_b16 v[130:131], v9 offset:512
  ds_read_b64_tr_b16 v[156:157], v9 offset:32
  ds_read_b64_tr_b16 v[158:159], v9 offset:544
  ds_read_b64_tr_b16 v[184:185], v9 offset:64
  ds_read_b64_tr_b16 v[186:187], v9 offset:576
  ds_read_b64_tr_b16 v[212:213], v9 offset:96
  ds_read_b64_tr_b16 v[214:215], v9 offset:608
  s_waitcnt lgkmcnt(6)
  s_waitcnt vmcnt(20)
  ds_read_b64_tr_b16 v[132:133], v9 offset:4096
  ds_read_b64_tr_b16 v[134:135], v9 offset:4608
  ds_read_b64_tr_b16 v[160:161], v9 offset:4128
  ds_read_b64_tr_b16 v[162:163], v9 offset:4640
  ds_read_b64_tr_b16 v[188:189], v9 offset:4160
  ds_read_b64_tr_b16 v[190:191], v9 offset:4672
  ds_read_b64_tr_b16 v[216:217], v9 offset:4192
  ds_read_b64_tr_b16 v[218:219], v9 offset:4704
  s_waitcnt lgkmcnt(8)
  v_mfma_f32_16x16x32_bf16 v[40:43], v[128:131], v[64:67], 0
  v_mul_f32 v24, s72, v24
  v_mfma_f32_16x16x32_bf16 v[44:47], v[156:159], v[64:67], 0
  v_mul_f32 v25, s72, v25
  v_mfma_f32_16x16x32_bf16 v[48:51], v[184:187], v[64:67], 0
  v_fma_f32 v25, -v24, v24, v25
  v_mfma_f32_16x16x32_bf16 v[52:55], v[212:215], v[64:67], 0
  v_max_f32 v25, 0, v25
  s_waitcnt lgkmcnt(6)
  s_waitcnt vmcnt(16)
  ds_read_b64_tr_b16 v[136:137], v9 offset:8192
  ds_read_b64_tr_b16 v[138:139], v9 offset:8704
  ds_read_b64_tr_b16 v[164:165], v9 offset:8224
  ds_read_b64_tr_b16 v[166:167], v9 offset:8736
  ds_read_b64_tr_b16 v[192:193], v9 offset:8256
  ds_read_b64_tr_b16 v[194:195], v9 offset:8768
  ds_read_b64_tr_b16 v[220:221], v9 offset:8288
  ds_read_b64_tr_b16 v[222:223], v9 offset:8800
  s_waitcnt lgkmcnt(8)
  v_mfma_f32_16x16x32_bf16 v[40:43], v[132:135], v[68:71], v[40:43]
  v_cvt_pk_bf16_f32 v25, v25, v25
  v_mfma_f32_16x16x32_bf16 v[44:47], v[160:163], v[68:71], v[44:47]
  v_lshlrev_b32 v25, 16, v25
  v_mfma_f32_16x16x32_bf16 v[48:51], v[188:191], v[68:71], v[48:51]
  v_add_f32 v25, s73, v25
  v_mfma_f32_16x16x32_bf16 v[52:55], v[216:219], v[68:71], v[52:55]
  v_cvt_pk_bf16_f32 v25, v25, v25
  s_waitcnt lgkmcnt(6)
  s_waitcnt vmcnt(12)
  ds_read_b64_tr_b16 v[140:141], v9 offset:12288
  ds_read_b64_tr_b16 v[142:143], v9 offset:12800
  ds_read_b64_tr_b16 v[168:169], v9 offset:12320
  ds_read_b64_tr_b16 v[170:171], v9 offset:12832
  ds_read_b64_tr_b16 v[196:197], v9 offset:12352
  ds_read_b64_tr_b16 v[198:199], v9 offset:12864
  ds_read_b64_tr_b16 v[224:225], v9 offset:12384
  ds_read_b64_tr_b16 v[226:227], v9 offset:12896
  s_waitcnt lgkmcnt(8)
  v_mfma_f32_16x16x32_bf16 v[40:43], v[136:139], v[72:75], v[40:43]
  v_lshlrev_b32 v25, 16, v25
  v_mfma_f32_16x16x32_bf16 v[44:47], v[164:167], v[72:75], v[44:47]
  v_sqrt_f32 v25, v25
  v_mfma_f32_16x16x32_bf16 v[48:51], v[192:195], v[72:75], v[48:51]
  v_cvt_pk_bf16_f32 v25, v25, v25
  v_mfma_f32_16x16x32_bf16 v[52:55], v[220:223], v[72:75], v[52:55]
  v_lshlrev_b32 v25, 16, v25
  s_waitcnt lgkmcnt(6)
  s_waitcnt vmcnt(8)
  ds_read_b64_tr_b16 v[144:145], v9 offset:16384
  ds_read_b64_tr_b16 v[146:147], v9 offset:16896
  ds_read_b64_tr_b16 v[172:173], v9 offset:16416
  ds_read_b64_tr_b16 v[174:175], v9 offset:16928
  ds_read_b64_tr_b16 v[200:201], v9 offset:16448
  ds_read_b64_tr_b16 v[202:203], v9 offset:16960
  ds_read_b64_tr_b16 v[228:229], v9 offset:16480
  ds_read_b64_tr_b16 v[230:231], v9 offset:16992
  s_waitcnt lgkmcnt(8)
  v_mfma_f32_16x16x32_bf16 v[40:43], v[140:143], v[76:79], v[40:43]
  v_rcp_f32 v25, v25
  v_mfma_f32_16x16x32_bf16 v[44:47], v[168:171], v[76:79], v[44:47]
  v_cvt_pk_bf16_f32 v24, v24, v24
  v_mfma_f32_16x16x32_bf16 v[48:51], v[196:199], v[76:79], v[48:51]
  v_lshlrev_b32 v24, 16, v24
  v_mfma_f32_16x16x32_bf16 v[52:55], v[224:227], v[76:79], v[52:55]
  s_waitcnt lgkmcnt(6)
  s_waitcnt vmcnt(4)
  ds_read_b64_tr_b16 v[148:149], v9 offset:20480
  ds_read_b64_tr_b16 v[150:151], v9 offset:20992
  ds_read_b64_tr_b16 v[176:177], v9 offset:20512
  ds_read_b64_tr_b16 v[178:179], v9 offset:21024
  ds_read_b64_tr_b16 v[204:205], v9 offset:20544
  ds_read_b64_tr_b16 v[206:207], v9 offset:21056
  ds_read_b64_tr_b16 v[232:233], v9 offset:20576
  ds_read_b64_tr_b16 v[234:235], v9 offset:21088
  s_waitcnt lgkmcnt(8)
  v_mfma_f32_16x16x32_bf16 v[40:43], v[144:147], v[80:83], v[40:43]
  v_mfma_f32_16x16x32_bf16 v[44:47], v[172:175], v[80:83], v[44:47]
  v_mfma_f32_16x16x32_bf16 v[48:51], v[200:203], v[80:83], v[48:51]
  v_mfma_f32_16x16x32_bf16 v[52:55], v[228:231], v[80:83], v[52:55]
  s_waitcnt lgkmcnt(6)
  s_waitcnt vmcnt(0)
  ds_read_b64_tr_b16 v[152:153], v9 offset:24576
  ds_read_b64_tr_b16 v[154:155], v9 offset:25088
  ds_read_b64_tr_b16 v[180:181], v9 offset:24608
  ds_read_b64_tr_b16 v[182:183], v9 offset:25120
  ds_read_b64_tr_b16 v[208:209], v9 offset:24640
  ds_read_b64_tr_b16 v[210:211], v9 offset:25152
  ds_read_b64_tr_b16 v[236:237], v9 offset:24672
  ds_read_b64_tr_b16 v[238:239], v9 offset:25184
  s_waitcnt lgkmcnt(8)
  v_mfma_f32_16x16x32_bf16 v[40:43], v[148:151], v[84:87], v[40:43]
  v_mfma_f32_16x16x32_bf16 v[44:47], v[176:179], v[84:87], v[44:47]
  v_mfma_f32_16x16x32_bf16 v[48:51], v[204:207], v[84:87], v[48:51]
  v_mfma_f32_16x16x32_bf16 v[52:55], v[232:235], v[84:87], v[52:55]
  s_waitcnt lgkmcnt(0)
  v_mfma_f32_16x16x32_bf16 v[40:43], v[152:155], v[88:91], v[40:43]
  v_mfma_f32_16x16x32_bf16 v[44:47], v[180:183], v[88:91], v[44:47]
  v_mfma_f32_16x16x32_bf16 v[48:51], v[208:211], v[88:91], v[48:51]
  v_mfma_f32_16x16x32_bf16 v[52:55], v[236:239], v[88:91], v[52:55]
  s_nop 4
  v_mul_f32_dpp v26, v40, v24 row_ror:8 row_mask:0xf bank_mask:0xf
  v_sub_f32 v40, v40, v26
  v_mul_f32 v40, v40, v25
  v_mul_f32_dpp v26, v41, v24 row_ror:8 row_mask:0xf bank_mask:0xf
  v_sub_f32 v41, v41, v26
  v_mul_f32 v41, v41, v25
  v_mul_f32_dpp v26, v42, v24 row_ror:8 row_mask:0xf bank_mask:0xf
  v_sub_f32 v42, v42, v26
  v_mul_f32 v42, v42, v25
  v_mul_f32_dpp v26, v43, v24 row_ror:8 row_mask:0xf bank_mask:0xf
  v_sub_f32 v43, v43, v26
  v_mul_f32 v43, v43, v25
  v_mul_f32_dpp v26, v44, v24 row_ror:8 row_mask:0xf bank_mask:0xf
  v_sub_f32 v44, v44, v26
  v_mul_f32 v44, v44, v25
  v_mul_f32_dpp v26, v45, v24 row_ror:8 row_mask:0xf bank_mask:0xf
  v_sub_f32 v45, v45, v26
  v_mul_f32 v45, v45, v25
  v_mul_f32_dpp v26, v46, v24 row_ror:8 row_mask:0xf bank_mask:0xf
  v_sub_f32 v46, v46, v26
  v_mul_f32 v46, v46, v25
  v_mul_f32_dpp v26, v47, v24 row_ror:8 row_mask:0xf bank_mask:0xf
  v_sub_f32 v47, v47, v26
  v_mul_f32 v47, v47, v25
  v_mul_f32_dpp v26, v48, v24 row_ror:8 row_mask:0xf bank_mask:0xf
  v_sub_f32 v48, v48, v26
  v_mul_f32 v48, v48, v25
  v_mul_f32_dpp v26, v49, v24 row_ror:8 row_mask:0xf bank_mask:0xf
  v_sub_f32 v49, v49, v26
  v_mul_f32 v49, v49, v25
  v_mul_f32_dpp v26, v50, v24 row_ror:8 row_mask:0xf bank_mask:0xf
  v_sub_f32 v50, v50, v26
  v_mul_f32 v50, v50, v25
  v_mul_f32_dpp v26, v51, v24 row_ror:8 row_mask:0xf bank_mask:0xf
  v_sub_f32 v51, v51, v26
  v_mul_f32 v51, v51, v25
  v_mul_f32_dpp v26, v52, v24 row_ror:8 row_mask:0xf bank_mask:0xf
  v_sub_f32 v52, v52, v26
  v_mul_f32 v52, v52, v25
  v_mul_f32_dpp v26, v53, v24 row_ror:8 row_mask:0xf bank_mask:0xf
  v_sub_f32 v53, v53, v26
  v_mul_f32 v53, v53, v25
  v_mul_f32_dpp v26, v54, v24 row_ror:8 row_mask:0xf bank_mask:0xf
  v_sub_f32 v54, v54, v26
  v_mul_f32 v54, v54, v25
  v_mul_f32_dpp v26, v55, v24 row_ror:8 row_mask:0xf bank_mask:0xf
  v_sub_f32 v55, v55, v26
  v_mul_f32 v55, v55, v25
  v_mov_b32_dpp v40, v44 row_ror:8 row_mask:0xf bank_mask:0xc
  v_mov_b32_dpp v41, v45 row_ror:8 row_mask:0xf bank_mask:0xc
  v_mov_b32_dpp v42, v46 row_ror:8 row_mask:0xf bank_mask:0xc
  v_mov_b32_dpp v43, v47 row_ror:8 row_mask:0xf bank_mask:0xc
  buffer_store_dwordx4 v[40:43], v10, s[48:51], 0 offen offset:0 sc1
  v_mov_b32_dpp v48, v52 row_ror:8 row_mask:0xf bank_mask:0xc
  v_mov_b32_dpp v49, v53 row_ror:8 row_mask:0xf bank_mask:0xc
  v_mov_b32_dpp v50, v54 row_ror:8 row_mask:0xf bank_mask:0xc
  v_mov_b32_dpp v51, v55 row_ror:8 row_mask:0xf bank_mask:0xc
  buffer_store_dwordx4 v[48:51], v10, s[48:51], 0 offen offset:128 sc1
  v_mov_b32 v16, s56
  v_mov_b32 v17, s58
  s_waitcnt vmcnt(0)
  s_mov_b32 s67, 0
  s_mov_b64 exec, s[66:67]
  buffer_store_dwordx2 v[16:17], v13, s[48:51], s75 offen sc1
  s_mov_b64 exec, -1
  s_branch L_hpre
L_h0late:
  s_waitcnt lgkmcnt(0)
  s_lshl_b32 s56, s52, 1
  s_sub_u32 s56, s56, s38
  s_add_u32 s56, s56, 1
  s_lshl_b32 s58, s53, 1
  s_sub_u32 s58, s58, s39
  s_add_u32 s58, s58, 1
  s_and_b32 s57, s58, 0xff
  s_mov_b32 s59, 0xffffff00
  s_barrier
  s_cmp_ge_u32 s5, 30
  s_cbranch_scc1 L_hpre
  s_sub_u32 s82, s5, 23
  s_mov_b32 s40, s30
  s_and_b32 s41, s31, 0xffff
  s_mov_b32 s42, 1605632
  s_mov_b32 s43, 0x20000
  s_mov_b32 s10, 896
  s_mul_i32 s11, s4, 200704
  s_lshl_b32 s12, s82, 7
  s_add_u32 s11, s11, s12
  s_mul_i32 s13, s4, 14336
  s_lshl_b32 s12, s82, 8
  s_add_u32 s13, s13, s12
  s_add_u32 s13, s13, 458752
  s_mov_b32 s14, 1792
  s_mul_i32 s75, s4, 4352
  s_add_u32 s75, s75, 4472832
  v_min_u32 v18, 7, v0
  v_lshlrev_b32 v18, 3, v18
  s_mov_b32 s80, 0
  s_nop 0
L_hf_3:
  buffer_load_dwordx2 v[16:17], v18, s[48:51], s75 offen sc1
  s_waitcnt vmcnt(0)
  v_xor_b32 v16, s56, v16
  v_xor_b32 v17, s58, v17
  v_or_b32 v16, v16, v17
  v_cmp_ne_u32 vcc, 0, v16
  s_nop 4
  s_cbranch_vccz L_hf_ok_4
  s_add_u32 s80, s80, 1
  s_cmp_ge_u32 s80, 131072
  s_cbranch_scc1 L_hf_ok_4
  s_sleep 32
  s_branch L_hf_3
L_hf_ok_4:
  v_and_b32 v14, 7, v0
  v_mul_u32_u24 v14, 7168, v14
  v_lshl_add_u32 v14, v3, 5, v14
  v_bfe_u32 v15, v0, 3, 1
  v_lshl_add_u32 v14, v15, 4, v14
  s_mul_i32 s72, s4, 896
  s_add_u32 s72, s72, 327680
  s_add_u32 s73, s72, 57344
  buffer_load_dwordx4 v[64:67], v14, s[48:51], s72 offen offset:0 sc1
  buffer_load_dwordx4 v[68:71], v14, s[48:51], s72 offen offset:128 sc1
  buffer_load_dwordx4 v[72:75], v14, s[48:51], s72 offen offset:256 sc1
  buffer_load_dwordx4 v[76:79], v14, s[48:51], s72 offen offset:384 sc1
  buffer_load_dwordx4 v[80:83], v14, s[48:51], s72 offen offset:512 sc1
  buffer_load_dwordx4 v[84:87], v14, s[48:51], s72 offen offset:640 sc1
  buffer_load_dwordx4 v[88:91], v14, s[48:51], s72 offen offset:768 sc1
  buffer_load_dwordx4 v[92:95], v14, s[48:51], s73 offen offset:0 sc1
  buffer_load_dwordx4 v[96:99], v14, s[48:51], s73 offen offset:128 sc1
  buffer_load_dwordx4 v[100:103], v14, s[48:51], s73 offen offset:256 sc1
  buffer_load_dwordx4 v[104:107], v14, s[48:51], s73 offen offset:384 sc1
  buffer_load_dwordx4 v[108:111], v14, s[48:51], s73 offen offset:512 sc1
  buffer_load_dwordx4 v[112:115], v14, s[48:51], s73 offen offset:640 sc1
  buffer_load_dwordx4 v[116:119], v14, s[48:51], s73 offen offset:768 sc1
  v_lshrrev_b32 v8, 3, v0
  v_mul_lo_u32 v8, v8, s10
  v_and_b32 v9, 7, v0
  v_lshl_add_u32 v8, v9, 4, v8
  s_lshl_b32 s72, s10, 3
  s_mov_b32 m0, 114688
  s_nop 0
  buffer_load_dwordx4 v8, s[40:43], s11 offen nt lds
  s_add_u32 s11, s11, s72
  s_mov_b32 m0, 115712
  s_nop 0
  buffer_load_dwordx4 v8, s[40:43], s11 offen nt lds
  s_add_u32 s11, s11, s72
  s_mov_b32 m0, 116736
  s_nop 0
  buffer_load_dwordx4 v8, s[40:43], s11 offen nt lds
  s_add_u32 s11, s11, s72
  s_mov_b32 m0, 117760
  s_nop 0
  buffer_load_dwordx4 v8, s[40:43], s11 offen nt lds
  s_add_u32 s11, s11, s72
  s_mov_b32 m0, 118784
  s_nop 0
  buffer_load_dwordx4 v8, s[40:43], s11 offen nt lds
  s_add_u32 s11, s11, s72
  s_mov_b32 m0, 119808
  s_nop 0
  buffer_load_dwordx4 v8, s[40:43], s11 offen nt lds
  s_add_u32 s11, s11, s72
  s_mov_b32 m0, 120832
  s_nop 0
  buffer_load_dwordx4 v8, s[40:43], s11 offen nt lds
  s_add_u32 s11, s11, s72
  s_mov_b32 m0, 121856
  s_nop 0
  buffer_load_dwordx4 v8, s[40:43], s11 offen nt lds
  s_add_u32 s11, s11, s72
  s_mov_b32 m0, 122880
  s_nop 0
  buffer_load_dwordx4 v8, s[40:43], s11 offen nt lds
  s_add_u32 s11, s11, s72
  s_mov_b32 m0, 123904
  s_nop 0
  buffer_load_dwordx4 v8, s[40:43], s11 offen nt lds
  s_add_u32 s11, s11, s72
  s_mov_b32 m0, 124928
  s_nop 0
  buffer_load_dwordx4 v8, s[40:43], s11 offen nt lds
  s_add_u32 s11, s11, s72
  s_mov_b32 m0, 125952
  s_nop 0
  buffer_load_dwordx4 v8, s[40:43], s11 offen nt lds
  s_add_u32 s11, s11, s72
  s_mov_b32 m0, 126976
  s_nop 0
  buffer_load_dwordx4 v8, s[40:43], s11 offen nt lds
  s_add_u32 s11, s11, s72
  s_mov_b32 m0, 128000
  s_nop 0
  buffer_load_dwordx4 v8, s[40:43], s11 offen nt lds
  s_add_u32 s11, s11, s72
  s_mov_b32 m0, 129024
  s_nop 0
  buffer_load_dwordx4 v8, s[40:43], s11 offen nt lds
  s_add_u32 s11, s11, s72
  s_mov_b32 m0, 130048
  s_nop 0
  buffer_load_dwordx4 v8, s[40:43], s11 offen nt lds
  s_add_u32 s11, s11, s72
  s_mov_b32 m0, 131072
  s_nop 0
  buffer_load_dwordx4 v8, s[40:43], s11 offen nt lds
  s_add_u32 s11, s11, s72
  s_mov_b32 m0, 132096
  s_nop 0
  buffer_load_dwordx4 v8, s[40:43], s11 offen nt lds
  s_add_u32 s11, s11, s72
  s_mov_b32 m0, 133120
  s_nop 0
  buffer_load_dwordx4 v8, s[40:43], s11 offen nt lds
  s_add_u32 s11, s11, s72
  s_mov_b32 m0, 134144
  s_nop 0
  buffer_load_dwordx4 v8, s[40:43], s11 offen nt lds
  s_add_u32 s11, s11, s72
  s_mov_b32 m0, 135168
  s_nop 0
  buffer_load_dwordx4 v8, s[40:43], s11 offen nt lds
  s_add_u32 s11, s11, s72
  s_mov_b32 m0, 136192
  s_nop 0
  buffer_load_dwordx4 v8, s[40:43], s11 offen nt lds
  s_add_u32 s11, s11, s72
  s_mov_b32 m0, 137216
  s_nop 0
  buffer_load_dwordx4 v8, s[40:43], s11 offen nt lds
  s_add_u32 s11, s11, s72
  s_mov_b32 m0, 138240
  s_nop 0
  buffer_load_dwordx4 v8, s[40:43], s11 offen nt lds
  s_add_u32 s11, s11, s72
  s_mov_b32 m0, 139264
  s_nop 0
  buffer_load_dwordx4 v8, s[40:43], s11 offen nt lds
  s_add_u32 s11, s11, s72
  s_mov_b32 m0, 140288
  s_nop 0
  buffer_load_dwordx4 v8, s[40:43], s11 offen nt lds
  s_add_u32 s11, s11, s72
  s_mov_b32 m0, 141312
  s_nop 0
  buffer_load_dwordx4 v8, s[40:43], s11 offen nt lds
  s_add_u32 s11, s11, s72
  s_mov_b32 m0, 142336
  s_nop 0
  buffer_load_dwordx4 v8, s[40:43], s11 offen nt lds
  s_add_u32 s11, s11, s72
  v_lshl_add_u32 v9, v3, 3, v4
  v_lshlrev_b32 v9, 7, v9
  v_lshl_add_u32 v9, v5, 3, v9
  v_add_u32 v9, 114688, v9
  v_and_b32 v10, 7, v0
  v_mul_lo_u32 v10, v10, s14
  v_bfe_u32 v11, v0, 3, 1
  v_lshl_add_u32 v10, v11, 6, v10
  v_lshl_add_u32 v10, v3, 4, v10
  v_add_u32 v10, s13, v10
  s_mul_i32 s75, s82, 34816
  s_lshl_b32 s12, s4, 3
  s_add_u32 s75, s75, s12
  s_add_u32 s75, s75, 4507648
  v_mul_u32_u24 v13, 4352, v0
  s_mov_b32 s66, 0xff
  s_waitcnt vmcnt(28)
  v_add_f32 v64, v64, v92
  v_add_f32 v65, v65, v93
  v_add_f32 v66, v66, v94
  v_add_f32 v67, v67, v95
  v_max_f32 v64, 0, v64
  v_max_f32 v65, 0, v65
  v_max_f32 v66, 0, v66
  v_max_f32 v67, 0, v67
  v_cvt_pk_bf16_f32 v64, v64, v65
  v_cvt_pk_bf16_f32 v65, v66, v67
  s_nop 0
  v_mov_b32_dpp v66, v64 row_ror:8 row_mask:0xf bank_mask:0xf
  v_mov_b32_dpp v67, v65 row_ror:8 row_mask:0xf bank_mask:0xf
  v_add_f32 v68, v68, v96
  v_add_f32 v69, v69, v97
  v_add_f32 v70, v70, v98
  v_add_f32 v71, v71, v99
  v_max_f32 v68, 0, v68
  v_max_f32 v69, 0, v69
  v_max_f32 v70, 0, v70
  v_max_f32 v71, 0, v71
  v_cvt_pk_bf16_f32 v68, v68, v69
  v_cvt_pk_bf16_f32 v69, v70, v71
  s_nop 0
  v_mov_b32_dpp v70, v68 row_ror:8 row_mask:0xf bank_mask:0xf
  v_mov_b32_dpp v71, v69 row_ror:8 row_mask:0xf bank_mask:0xf
  v_add_f32 v72, v72, v100
  v_add_f32 v73, v73, v101
  v_add_f32 v74, v74, v102
  v_add_f32 v75, v75, v103
  v_max_f32 v72, 0, v72
  v_max_f32 v73, 0, v73
  v_max_f32 v74, 0, v74
  v_max_f32 v75, 0, v75
  v_cvt_pk_bf16_f32 v72, v72, v73
  v_cvt_pk_bf16_f32 v73, v74, v75
  s_nop 0
  v_mov_b32_dpp v74, v72 row_ror:8 row_mask:0xf bank_mask:0xf
  v_mov_b32_dpp v75, v73 row_ror:8 row_mask:0xf bank_mask:0xf
  v_add_f32 v76, v76, v104
  v_add_f32 v77, v77, v105
  v_add_f32 v78, v78, v106
  v_add_f32 v79, v79, v107
  v_max_f32 v76, 0, v76
  v_max_f32 v77, 0, v77
  v_max_f32 v78, 0, v78
  v_max_f32 v79, 0, v79
  v_cvt_pk_bf16_f32 v76, v76, v77
  v_cvt_pk_bf16_f32 v77, v78, v79
  s_nop 0
  v_mov_b32_dpp v78, v76 row_ror:8 row_mask:0xf bank_mask:0xf
  v_mov_b32_dpp v79, v77 row_ror:8 row_mask:0xf bank_mask:0xf
  v_add_f32 v80, v80, v108
  v_add_f32 v81, v81, v109
  v_add_f32 v82, v82, v110
  v_add_f32 v83, v83, v111
  v_max_f32 v80, 0, v80
  v_max_f32 v81, 0, v81
  v_max_f32 v82, 0, v82
  v_max_f32 v83, 0, v83
  v_cvt_pk_bf16_f32 v80, v80, v81
  v_cvt_pk_bf16_f32 v81, v82, v83
  s_nop 0
  v_mov_b32_dpp v82, v80 row_ror:8 row_mask:0xf bank_mask:0xf
  v_mov_b32_dpp v83, v81 row_ror:8 row_mask:0xf bank_mask:0xf
  v_add_f32 v84, v84, v112
  v_add_f32 v85, v85, v113
  v_add_f32 v86, v86, v114
  v_add_f32 v87, v87, v115
  v_max_f32 v84, 0, v84
  v_max_f32 v85, 0, v85
  v_max_f32 v86, 0, v86
  v_max_f32 v87, 0, v87
  v_cvt_pk_bf16_f32 v84, v84, v85
  v_cvt_pk_bf16_f32 v85, v86, v87
  s_nop 0
  v_mov_b32_dpp v86, v84 row_ror:8 row_mask:0xf bank_mask:0xf
  v_mov_b32_dpp v87, v85 row_ror:8 row_mask:0xf bank_mask:0xf
  v_add_f32 v88, v88, v116
  v_add_f32 v89, v89, v117
  v_add_f32 v90, v90, v118
  v_add_f32 v91, v91, v119
  v_max_f32 v88, 0, v88
  v_max_f32 v89, 0, v89
  v_max_f32 v90, 0, v90
  v_max_f32 v91, 0, v91
  v_cvt_pk_bf16_f32 v88, v88, v89
  v_cvt_pk_bf16_f32 v89, v90, v91
  s_nop 0
  v_mov_b32_dpp v90, v88 row_ror:8 row_mask:0xf bank_mask:0xf
  v_mov_b32_dpp v91, v89 row_ror:8 row_mask:0xf bank_mask:0xf
  s_waitcnt vmcnt(24)
  ds_read_b64_tr_b16 v[128:129], v9 offset:0
  ds_read_b64_tr_b16 v[130:131], v9 offset:512
  ds_read_b64_tr_b16 v[156:157], v9 offset:32
  ds_read_b64_tr_b16 v[158:159], v9 offset:544
  ds_read_b64_tr_b16 v[184:185], v9 offset:64
  ds_read_b64_tr_b16 v[186:187], v9 offset:576
  ds_read_b64_tr_b16 v[212:213], v9 offset:96
  ds_read_b64_tr_b16 v[214:215], v9 offset:608
  s_waitcnt lgkmcnt(6)
  s_waitcnt vmcnt(20)
  ds_read_b64_tr_b16 v[132:133], v9 offset:4096
  ds_read_b64_tr_b16 v[134:135], v9 offset:4608
  ds_read_b64_tr_b16 v[160:161], v9 offset:4128
  ds_read_b64_tr_b16 v[162:163], v9 offset:4640
  ds_read_b64_tr_b16 v[188:189], v9 offset:4160
  ds_read_b64_tr_b16 v[190:191], v9 offset:4672
  ds_read_b64_tr_b16 v[216:217], v9 offset:4192
  ds_read_b64_tr_b16 v[218:219], v9 offset:4704
  s_waitcnt lgkmcnt(8)
  v_mfma_f32_16x16x32_bf16 v[40:43], v[128:131], v[64:67], 0
  v_mfma_f32_16x16x32_bf16 v[44:47], v[156:159], v[64:67], 0
  v_mfma_f32_16x16x32_bf16 v[48:51], v[184:187], v[64:67], 0
  v_mfma_f32_16x16x32_bf16 v[52:55], v[212:215], v[64:67], 0
  s_waitcnt lgkmcnt(6)
  s_waitcnt vmcnt(16)
  ds_read_b64_tr_b16 v[136:137], v9 offset:8192
  ds_read_b64_tr_b16 v[138:139], v9 offset:8704
  ds_read_b64_tr_b16 v[164:165], v9 offset:8224
  ds_read_b64_tr_b16 v[166:167], v9 offset:8736
  ds_read_b64_tr_b16 v[192:193], v9 offset:8256
  ds_read_b64_tr_b16 v[194:195], v9 offset:8768
  ds_read_b64_tr_b16 v[220:221], v9 offset:8288
  ds_read_b64_tr_b16 v[222:223], v9 offset:8800
  s_waitcnt lgkmcnt(8)
  v_mfma_f32_16x16x32_bf16 v[40:43], v[132:135], v[68:71], v[40:43]
  v_mfma_f32_16x16x32_bf16 v[44:47], v[160:163], v[68:71], v[44:47]
  v_mfma_f32_16x16x32_bf16 v[48:51], v[188:191], v[68:71], v[48:51]
  v_mfma_f32_16x16x32_bf16 v[52:55], v[216:219], v[68:71], v[52:55]
  s_waitcnt lgkmcnt(6)
  s_waitcnt vmcnt(12)
  ds_read_b64_tr_b16 v[140:141], v9 offset:12288
  ds_read_b64_tr_b16 v[142:143], v9 offset:12800
  ds_read_b64_tr_b16 v[168:169], v9 offset:12320
  ds_read_b64_tr_b16 v[170:171], v9 offset:12832
  ds_read_b64_tr_b16 v[196:197], v9 offset:12352
  ds_read_b64_tr_b16 v[198:199], v9 offset:12864
  ds_read_b64_tr_b16 v[224:225], v9 offset:12384
  ds_read_b64_tr_b16 v[226:227], v9 offset:12896
  s_waitcnt lgkmcnt(8)
  v_mfma_f32_16x16x32_bf16 v[40:43], v[136:139], v[72:75], v[40:43]
  v_mfma_f32_16x16x32_bf16 v[44:47], v[164:167], v[72:75], v[44:47]
  v_mfma_f32_16x16x32_bf16 v[48:51], v[192:195], v[72:75], v[48:51]
  v_mfma_f32_16x16x32_bf16 v[52:55], v[220:223], v[72:75], v[52:55]
  s_waitcnt lgkmcnt(6)
  s_waitcnt vmcnt(8)
  ds_read_b64_tr_b16 v[144:145], v9 offset:16384
  ds_read_b64_tr_b16 v[146:147], v9 offset:16896
  ds_read_b64_tr_b16 v[172:173], v9 offset:16416
  ds_read_b64_tr_b16 v[174:175], v9 offset:16928
  ds_read_b64_tr_b16 v[200:201], v9 offset:16448
  ds_read_b64_tr_b16 v[202:203], v9 offset:16960
  ds_read_b64_tr_b16 v[228:229], v9 offset:16480
  ds_read_b64_tr_b16 v[230:231], v9 offset:16992
  s_waitcnt lgkmcnt(8)
  v_mfma_f32_16x16x32_bf16 v[40:43], v[140:143], v[76:79], v[40:43]
  v_mfma_f32_16x16x32_bf16 v[44:47], v[168:171], v[76:79], v[44:47]
  v_mfma_f32_16x16x32_bf16 v[48:51], v[196:199], v[76:79], v[48:51]
  v_mfma_f32_16x16x32_bf16 v[52:55], v[224:227], v[76:79], v[52:55]
  s_waitcnt lgkmcnt(6)
  s_waitcnt vmcnt(4)
  ds_read_b64_tr_b16 v[148:149], v9 offset:20480
  ds_read_b64_tr_b16 v[150:151], v9 offset:20992
  ds_read_b64_tr_b16 v[176:177], v9 offset:20512
  ds_read_b64_tr_b16 v[178:179], v9 offset:21024
  ds_read_b64_tr_b16 v[204:205], v9 offset:20544
  ds_read_b64_tr_b16 v[206:207], v9 offset:21056
  ds_read_b64_tr_b16 v[232:233], v9 offset:20576
  ds_read_b64_tr_b16 v[234:235], v9 offset:21088
  s_waitcnt lgkmcnt(8)
  v_mfma_f32_16x16x32_bf16 v[40:43], v[144:147], v[80:83], v[40:43]
  v_mfma_f32_16x16x32_bf16 v[44:47], v[172:175], v[80:83], v[44:47]
  v_mfma_f32_16x16x32_bf16 v[48:51], v[200:203], v[80:83], v[48:51]
  v_mfma_f32_16x16x32_bf16 v[52:55], v[228:231], v[80:83], v[52:55]
  s_waitcnt lgkmcnt(6)
  s_waitcnt vmcnt(0)
  ds_read_b64_tr_b16 v[152:153], v9 offset:24576
  ds_read_b64_tr_b16 v[154:155], v9 offset:25088
  ds_read_b64_tr_b16 v[180:181], v9 offset:24608
  ds_read_b64_tr_b16 v[182:183], v9 offset:25120
  ds_read_b64_tr_b16 v[208:209], v9 offset:24640
  ds_read_b64_tr_b16 v[210:211], v9 offset:25152
  ds_read_b64_tr_b16 v[236:237], v9 offset:24672
  ds_read_b64_tr_b16 v[238:239], v9 offset:25184
  s_waitcnt lgkmcnt(8)
  v_mfma_f32_16x16x32_bf16 v[40:43], v[148:151], v[84:87], v[40:43]
  v_mfma_f32_16x16x32_bf16 v[44:47], v[176:179], v[84:87], v[44:47]
  v_mfma_f32_16x16x32_bf16 v[48:51], v[204:207], v[84:87], v[48:51]
  v_mfma_f32_16x16x32_bf16 v[52:55], v[232:235], v[84:87], v[52:55]
  s_waitcnt lgkmcnt(0)
  v_mfma_f32_16x16x32_bf16 v[40:43], v[152:155], v[88:91], v[40:43]
  v_mfma_f32_16x16x32_bf16 v[44:47], v[180:183], v[88:91], v[44:47]
  v_mfma_f32_16x16x32_bf16 v[48:51], v[208:211], v[88:91], v[48:51]
  v_mfma_f32_16x16x32_bf16 v[52:55], v[236:239], v[88:91], v[52:55]
  s_nop 5
  v_mov_b32_dpp v40, v44 row_ror:8 row_mask:0xf bank_mask:0xc
  v_mov_b32_dpp v41, v45 row_ror:8 row_mask:0xf bank_mask:0xc
  v_mov_b32_dpp v42, v46 row_ror:8 row_mask:0xf bank_mask:0xc
  v_mov_b32_dpp v43, v47 row_ror:8 row_mask:0xf bank_mask:0xc
  buffer_store_dwordx4 v[40:43], v10, s[48:51], 0 offen offset:0 sc1
  v_mov_b32_dpp v48, v52 row_ror:8 row_mask:0xf bank_mask:0xc
  v_mov_b32_dpp v49, v53 row_ror:8 row_mask:0xf bank_mask:0xc
  v_mov_b32_dpp v50, v54 row_ror:8 row_mask:0xf bank_mask:0xc
  v_mov_b32_dpp v51, v55 row_ror:8 row_mask:0xf bank_mask:0xc
  buffer_store_dwordx4 v[48:51], v10, s[48:51], 0 offen offset:128 sc1
  v_mov_b32 v16, s56
  v_mov_b32 v17, s58
  s_waitcnt vmcnt(0)
  s_mov_b32 s67, 0
  s_mov_b64 exec, s[66:67]
  buffer_store_dwordx2 v[16:17], v13, s[48:51], s75 offen sc1
  s_mov_b64 exec, -1
  s_branch L_hpre
L_h123:
  s_cmp_eq_u32 s3, 6
  s_cbranch_scc1 L_h2
  s_waitcnt lgkmcnt(0)
  s_lshl_b32 s56, s52, 1
  s_sub_u32 s56, s56, s38
  s_add_u32 s56, s56, 1
  s_lshl_b32 s58, s53, 1
  s_sub_u32 s58, s58, s39
  s_add_u32 s58, s58, 1
  s_and_b32 s57, s58, 0xff
  s_mov_b32 s59, 0xffffff00
  s_barrier
  s_cmp_eq_u32 s3, 7
  s_cbranch_scc1 L_h3
L_h1w_5:
  ds_read_b32 v8, v2 offset:0
  s_waitcnt lgkmcnt(0)
  v_readfirstlane_b32 s13, v8
  s_nop 1
  s_cmp_lg_u32 s13, 0
  s_nop 1
  s_cbranch_scc1 L_h1w_ok_6
  s_sleep 8
  s_branch L_h1w_5
L_h1w_ok_6:
  s_mov_b32 s40, s24
  s_and_b32 s41, s25, 0xffff
  s_mov_b32 s42, 3670016
  s_mov_b32 s43, 0x20000
  v_mul_u32_u24 v8, 896, v3
  v_lshl_add_u32 v8, v6, 4, v8
  s_lshl_b32 s11, s4, 3
  s_add_u32 s11, s11, s6
  s_mul_i32 s11, s11, 57344
  s_mul_i32 s12, s7, 224
  s_add_u32 s11, s11, s12
  s_mov_b32 s70, 1073692671
  s_mov_b32 s71, 1073692671
  s_mov_b64 exec, s[70:71]
  s_mov_b32 m0, 143360
  s_nop 0
  buffer_load_dwordx4 v8, s[40:43], s11 offen nt lds
  s_add_u32 s11, s11, 3584
  s_mov_b32 m0, 144384
  s_nop 0
  buffer_load_dwordx4 v8, s[40:43], s11 offen nt lds
  s_add_u32 s11, s11, 3584
  s_mov_b32 m0, 145408
  s_nop 0
  buffer_load_dwordx4 v8, s[40:43], s11 offen nt lds
  s_add_u32 s11, s11, 3584
  s_mov_b32 m0, 146432
  s_nop 0
  buffer_load_dwordx4 v8, s[40:43], s11 offen nt lds
  s_add_u32 s11, s11, 3584
  s_mov_b32 m0, 147456
  s_nop 0
  buffer_load_dwordx4 v8, s[40:43], s11 offen nt lds
  s_add_u32 s11, s11, 3584
  s_mov_b32 m0, 148480
  s_nop 0
  buffer_load_dwordx4 v8, s[40:43], s11 offen nt lds
  s_add_u32 s11, s11, 3584
  s_mov_b32 m0, 149504
  s_nop 0
  buffer_load_dwordx4 v8, s[40:43], s11 offen nt lds
  s_add_u32 s11, s11, 3584
  s_mov_b32 m0, 150528
  s_nop 0
  buffer_load_dwordx4 v8, s[40:43], s11 offen nt lds
  s_add_u32 s11, s11, 3584
  s_mov_b32 m0, 151552
  s_nop 0
  buffer_load_dwordx4 v8, s[40:43], s11 offen nt lds
  s_add_u32 s11, s11, 3584
  s_mov_b32 m0, 152576
  s_nop 0
  buffer_load_dwordx4 v8, s[40:43], s11 offen nt lds
  s_add_u32 s11, s11, 3584
  s_mov_b32 m0, 153600
  s_nop 0
  buffer_load_dwordx4 v8, s[40:43], s11 offen nt lds
  s_add_u32 s11, s11, 3584
  s_mov_b32 m0, 154624
  s_nop 0
  buffer_load_dwordx4 v8, s[40:43], s11 offen nt lds
  s_add_u32 s11, s11, 3584
  s_mov_b32 m0, 155648
  s_nop 0
  buffer_load_dwordx4 v8, s[40:43], s11 offen nt lds
  s_add_u32 s11, s11, 3584
  s_mov_b32 m0, 156672
  s_nop 0
  buffer_load_dwordx4 v8, s[40:43], s11 offen nt lds
  s_add_u32 s11, s11, 3584
  s_mov_b32 m0, 157696
  s_nop 0
  buffer_load_dwordx4 v8, s[40:43], s11 offen nt lds
  s_add_u32 s11, s11, 3584
  s_mov_b32 m0, 158720
  s_nop 0
  buffer_load_dwordx4 v8, s[40:43], s11 offen nt lds
  s_add_u32 s11, s11, 3584
  s_mov_b64 exec, -1
  s_waitcnt vmcnt(0)
  s_branch L_hpre
L_h2:
  v_mov_b32 v8, 0
  v_mov_b32 v9, 0
  v_mov_b32 v10, 0
  v_mov_b32 v11, 0
  ds_write_b128 v2, v[8:11]
  ds_write_b64 v2, v[8:9] offset:16
  s_lshl_b32 s10, s6, 14
  s_lshl_b32 s11, s4, 11
  s_add_u32 s10, s10, s11
  s_add_u32 s10, s10, 4096
  s_add_u32 s11, s10, 0x20000
  v_lshlrev_b32 v9, 3, v0
  v_add_u32 v9, 159744, v9
  s_mul_i32 s75, s8, 4352
  s_add_u32 s75, s75, 4194304
  s_waitcnt lgkmcnt(0)
  s_lshl_b32 s56, s52, 1
  s_sub_u32 s56, s56, s38
  s_add_u32 s56, s56, 1
  s_lshl_b32 s58, s53, 1
  s_sub_u32 s58, s58, s39
  s_add_u32 s58, s58, 1
  s_and_b32 s57, s58, 0xff
  s_mov_b32 s59, 0xffffff00
  s_barrier
  v_min_u32 v18, 15, v0
  v_lshlrev_b32 v18, 3, v18
  s_mov_b32 s80, 0
  s_nop 0
L_qf_7:
  buffer_load_dwordx2 v[16:17], v18, s[48:51], s75 offen sc1
  s_waitcnt vmcnt(0)
  v_xor_b32 v16, s56, v16
  v_xor_b32 v17, s58, v17
  v_or_b32 v16, v16, v17
  v_cmp_ne_u32 vcc, 0, v16
  s_nop 4
  s_cbranch_vccz L_qf_ok_8
  s_add_u32 s80, s80, 1
  s_cmp_ge_u32 s80, 131072
  s_cbranch_scc1 L_qf_ok_8
  s_sleep 4
  s_branch L_qf_7
L_qf_ok_8:
  buffer_load_dwordx4 v[16:19], v7, s[48:51], s10 offen offset:0 sc1
  buffer_load_dwordx4 v[20:23], v7, s[48:51], s10 offen offset:1024 sc1
  buffer_load_dwordx4 v[24:27], v7, s[48:51], s11 offen offset:0 sc1
  buffer_load_dwordx4 v[28:31], v7, s[48:51], s11 offen offset:1024 sc1
  s_waitcnt vmcnt(0)
  v_add_f32 v16, v16, v24
  v_add_f32 v17, v17, v25
  v_add_f32 v18, v18, v26
  v_add_f32 v19, v19, v27
  v_add_f32 v20, v20, v28
  v_add_f32 v21, v21, v29
  v_add_f32 v22, v22, v30
  v_add_f32 v23, v23, v31
  v_cvt_pk_bf16_f32 v32, v16, v17
  v_cvt_pk_bf16_f32 v33, v18, v19
  ds_write_b64 v9, v[32:33] offset:0
  v_cvt_pk_bf16_f32 v34, v20, v21
  v_cvt_pk_bf16_f32 v35, v22, v23
  ds_write_b64 v9, v[34:35] offset:512
  s_waitcnt lgkmcnt(0)
  v_mov_b32 v8, 1
  ds_write_b32 v2, v8
  s_nop 0
L_kd_9:
  ds_read_b64 v[8:9], v2 offset:8
  ds_read_b64 v[10:11], v2 offset:16
  s_waitcnt lgkmcnt(0)
  v_and_b32 v8, v8, v9
  v_and_b32 v10, v10, v11
  v_and_b32 v8, v8, v10
  s_nop 0
  v_readfirstlane_b32 s13, v8
  s_nop 1
  s_cmp_lg_u32 s13, 0
  s_nop 1
  s_cbranch_scc1 L_kd_ok_10
  s_sleep 16
  s_branch L_kd_9
L_kd_ok_10:
  v_and_b32 v8, 7, v0
  v_lshlrev_b32 v9, 3, v8
  v_add_u32 v9, 160768, v9
  ds_read_b64 v[16:17], v9
  s_waitcnt lgkmcnt(0)
  v_mov_b32 v18, v16
  s_nop 1
  v_max_f32_dpp v18, v18, v18 quad_perm:[1,0,3,2] row_mask:0xf bank_mask:0xf
  s_nop 1
  v_max_f32_dpp v18, v18, v18 quad_perm:[2,3,0,1] row_mask:0xf bank_mask:0xf
  v_and_b32 v18, s59, v18
  v_sub_f32 v19, v16, v18
  v_exp_f32 v19, v19
  s_nop 0
  v_mul_f32 v19, v19, v17
  s_nop 1
  v_add_f32_dpp v19, v19, v19 quad_perm:[1,0,3,2] row_mask:0xf bank_mask:0xf
  s_nop 1
  v_add_f32_dpp v19, v19, v19 quad_perm:[2,3,0,1] row_mask:0xf bank_mask:0xf
  v_and_b32 v10, 1, v0
  v_cmp_eq_u32 vcc, 1, v10
  s_nop 1
  v_cndmask_b32 v20, v18, v19, vcc
  v_mov_b32 v11, s57
  v_and_or_b32 v20, v20, s59, v11
  v_mov_b32 v21, s56
  v_bfe_u32 v11, v0, 2, 1
  v_lshlrev_b32 v11, 4, v11
  v_lshl_add_u32 v11, v10, 3, v11
  s_mul_i32 s75, s8, 4352
  s_add_u32 s75, s75, 4751360
  s_lshl_b32 s72, s7, 5
  s_add_u32 s72, s72, s75
  s_mov_b64 exec, 0x33
  buffer_store_dwordx2 v[20:21], v11, s[48:51], s72 offen sc1
  s_mov_b64 exec, -1
  v_lshlrev_b32 v11, 3, v6
  s_mov_b32 s80, 0
  s_nop 0
L_sx_11:
  buffer_load_dwordx2 v[22:23], v11, s[48:51], s75 offen sc1
  s_waitcnt vmcnt(0)
  v_xor_b32 v26, s56, v23
  v_xor_b32 v27, s56, v23
  v_or_b32 v24, v26, v27
  v_xor_b32 v26, s57, v22
  v_xor_b32 v27, s57, v22
  v_or_b32 v25, v26, v27
  v_and_b32 v25, 0xff, v25
  v_or_b32 v24, v24, v25
  v_cmp_ne_u32 vcc, 0, v24
  s_nop 4
  s_cbranch_vccz L_sx_ok_12
  s_add_u32 s80, s80, 1
  s_cmp_ge_u32 s80, 131072
  s_cbranch_scc1 L_sx_ok_12
  s_sleep 16
  s_branch L_sx_11
L_sx_ok_12:
  v_and_b32 v22, s59, v22
  s_nop 1
  v_mov_b32_dpp v24, v22 quad_perm:[0,0,2,2] row_mask:0xf bank_mask:0xf
  v_mov_b32 v25, v24
  s_nop 1
  v_max_f32_dpp v25, v25, v25 row_ror:4 row_mask:0xf bank_mask:0xf
  s_nop 1
  v_max_f32_dpp v25, v25, v25 row_ror:8 row_mask:0xf bank_mask:0xf
  v_sub_f32 v24, v24, v25
  v_exp_f32 v24, v24
  s_nop 0
  v_mul_f32 v24, v24, v22
  s_nop 1
  v_add_f32_dpp v24, v24, v24 row_ror:4 row_mask:0xf bank_mask:0xf
  s_nop 1
  v_add_f32_dpp v24, v24, v24 row_ror:8 row_mask:0xf bank_mask:0xf
  v_readlane_b32 s72, v25, 0
  v_readlane_b32 s73, v24, 1
  v_readlane_b32 s74, v25, 2
  v_readlane_b32 s75, v24, 3
  v_bfe_u32 v10, v0, 2, 1
  v_cmp_eq_u32 vcc, 1, v10
  v_mov_b32 v24, s72
  v_mov_b32 v25, s74
  v_cndmask_b32 v24, v24, v25, vcc
  v_mov_b32 v25, s73
  v_mov_b32 v26, s75
  v_cndmask_b32 v25, v25, v26, vcc
  v_sub_f32 v16, v16, v24
  v_exp_f32 v16, v16
  v_rcp_f32 v25, v25
  s_nop 0
  v_mul_f32 v16, v16, v25
  v_lshlrev_b32 v9, 2, v8
  v_add_u32 v9, 160832, v9
  ds_write_b32 v9, v16
  s_nop 0
  s_branch L_hpre
L_h3:
  s_mul_i32 s85, s7, 7
  s_add_u32 s85, s85, s4
  s_mul_i32 s84, s6, 28
  s_add_u32 s84, s84, s85
  s_cmp_eq_u32 s4, 7
  s_cbranch_scc1 L_hpre
  s_mov_b32 s44, s16
  s_and_b32 s45, s17, 0xffff
  s_mov_b32 s46, 7168
  s_mov_b32 s47, 0x20000
  v_and_b32 v12, 7, v0
  v_lshlrev_b32 v12, 2, v12
  s_lshl_b32 s11, s84, 5
  v_add_u32 v12, s11, v12
  buffer_load_dword v13, v12, s[44:47], 0 offen
  s_lshr_b32 s75, s85, 2
  s_lshl_b32 s75, s75, 3
  s_add_u32 s75, s75, s6
  s_mul_i32 s75, s75, 4352
  s_add_u32 s75, s75, 4507648
  s_sleep 127
  v_min_u32 v18, 7, v0
  v_lshlrev_b32 v18, 3, v18
  s_mov_b32 s80, 0
  s_nop 0
L_ff_13:
  buffer_load_dwordx2 v[16:17], v18, s[48:51], s75 offen sc1
  s_waitcnt vmcnt(0)
  v_xor_b32 v16, s56, v16
  v_xor_b32 v17, s58, v17
  v_or_b32 v16, v16, v17
  v_cmp_ne_u32 vcc, 0, v16
  s_nop 4
  s_cbranch_vccz L_ff_ok_14
  s_add_u32 s80, s80, 1
  s_cmp_ge_u32 s80, 131072
  s_cbranch_scc1 L_ff_ok_14
  s_sleep 64
  s_branch L_ff_13
L_ff_ok_14:
  v_lshrrev_b32 v8, 3, v0
  v_mul_u32_u24 v8, 14336, v8
  v_and_b32 v9, 7, v0
  v_lshl_add_u32 v8, v9, 3, v8
  s_lshl_b32 s10, s84, 6
  s_add_u32 s10, s10, 458752
  buffer_load_dwordx2 v[16:17], v8, s[48:51], s10 offen sc1
  s_waitcnt vmcnt(0)
  v_add_f32_dpp v16, v16, v16 row_ror:8 row_mask:0xf bank_mask:0xf
  v_add_f32_dpp v17, v17, v17 row_ror:8 row_mask:0xf bank_mask:0xf
  v_mov_b32 v8, v16
  v_mov_b32 v9, v16
  s_nop 1
  v_permlane16_swap_b32 v8, v9
  v_add_f32 v16, v8, v9
  v_mov_b32 v10, v17
  v_mov_b32 v11, v17
  s_nop 1
  v_permlane16_swap_b32 v10, v11
  v_add_f32 v17, v10, v11
  v_mov_b32 v8, v16
  v_mov_b32 v9, v16
  s_nop 1
  v_permlane32_swap_b32 v8, v9
  v_add_f32 v16, v8, v9
  v_mov_b32 v10, v17
  v_mov_b32 v11, v17
  s_nop 1
  v_permlane32_swap_b32 v10, v11
  v_add_f32 v17, v10, v11
  s_mov_b32 s72, 0xbfb8aa3b
  v_cvt_pk_bf16_f32 v16, v16, v16
  v_lshlrev_b32 v16, 16, v16
  v_mul_f32 v8, s72, v16
  v_exp_f32 v8, v8
  s_nop 0
  v_add_f32 v8, 1.0, v8
  v_rcp_f32 v8, v8
  s_nop 0
  v_mul_f32 v14, v16, v8
  v_cvt_pk_bf16_f32 v14, v14, v14
  v_lshlrev_b32 v14, 16, v14
  v_cvt_pk_bf16_f32 v17, v17, v17
  v_lshlrev_b32 v17, 16, v17
  v_mul_f32 v8, s72, v17
  v_exp_f32 v8, v8
  s_nop 0
  v_add_f32 v8, 1.0, v8
  v_rcp_f32 v8, v8
  s_nop 0
  v_mul_f32 v15, v17, v8
  v_cvt_pk_bf16_f32 v15, v15, v15
  v_lshlrev_b32 v15, 16, v15
  s_nop 1
L_hpre:
  s_lshr_b32 s70, s3, 2
  s_bfe_u32 s71, s3, 0x10001
  s_and_b32 s72, s3, 1
  s_lshl_b32 s73, s71, 10
  s_lshl_b32 s74, s72, 9
  s_add_u32 s73, s73, s74
  s_lshl_b32 s74, s70, 7
  s_add_u32 s73, s73, s74
  v_lshrrev_b32 v38, 5, v0
  v_lshlrev_b32 v38, 8, v38
  v_and_b32 v39, 7, v0
  v_lshl_add_u32 v38, v39, 4, v38
  v_bfe_u32 v39, v0, 3, 2
  v_lshl_add_u32 v38, v39, 2, v38
  v_add_u32 v38, s73, v38
  s_lshl_b32 s73, s9, 11
  s_lshl_b32 s74, s3, 8
  s_add_u32 s73, s73, s74
  s_add_u32 s73, s73, 1048576
  v_lshlrev_b32 v39, 2, v0
  v_add_u32 v39, s73, v39
  s_lshl_b32 s74, s70, 4
  s_add_u32 s74, s74, 160832
  v_mov_b32 v37, s74
  v_lshlrev_b32 v40, 16, v3
  v_lshl_add_u32 v40, v6, 4, v40
  s_lshl_b32 s76, s4, 13
  s_lshl_b32 s72, s15, 11
  s_add_u32 s76, s76, s72
  s_lshl_b32 s72, s6, 8
  s_add_u32 s76, s76, s72
  s_add_u32 s76, s76, 1048576
  s_add_u32 s77, s76, 0x40000
  v_lshlrev_b32 v42, 7, v3
  v_lshl_add_u32 v42, v6, 3, v42
  s_lshl_b32 s72, s15, 10
  s_add_u32 s72, s72, 114688
  v_add_u32 v42, s72, v42
  v_and_b32 v8, 7, v0
  v_lshlrev_b32 v43, 7, v8
  v_lshl_add_u32 v43, v3, 4, v43
  v_add_u32 v43, 114688, v43
  v_lshl_add_u32 v44, v3, 3, v4
  v_lshlrev_b32 v44, 8, v44
  v_lshl_add_u32 v44, v5, 3, v44
  s_lshl_b32 s72, s15, 5
  s_add_u32 s72, s72, 143360
  v_add_u32 v44, s72, v44
  v_and_b32 v8, 1, v3
  v_lshlrev_b32 v8, 2, v8
  v_lshrrev_b32 v9, 1, v3
  v_lshl_add_u32 v8, v9, 1, v8
  s_mov_b32 s72, 229376
  v_mul_lo_u32 v45, v8, s72
  v_lshl_add_u32 v45, v6, 3, v45
  s_mul_i32 s72, s7, 7
  s_add_u32 s72, s72, s15
  s_lshl_b32 s72, s72, 6
  s_lshl_b32 s73, s4, 3
  s_add_u32 s72, s72, s73
  s_add_u32 s72, s72, s6
  s_lshl_b32 s72, s72, 7
  s_add_u32 s79, s72, 2097152
  s_add_u32 s78, s79, 32768
  v_add_u32 v46, 229376, v45
  s_mov_b32 s60, 0
  s_mov_b32 s61, -1
  v_mul_u32_u24 v47, 4352, v0
  s_mul_i32 s68, s7, 34816
  s_add_u32 s68, s68, 5169152
  s_lshl_b32 s72, s4, 3
  s_add_u32 s72, s72, s6
  s_lshl_b32 s72, s72, 2
  s_add_u32 s69, s68, s72
L_bar2:
  v_mov_b32 v36, s57
  v_mov_b32 v21, s56
  v_add_u32 v35, 57344, v38
  s_mov_b32 s62, 0x55555555
  s_mov_b32 s63, 0x55555555
  s_waitcnt lgkmcnt(0)
  s_barrier
  ds_read_b128 v[24:27], v37
  ds_read_b32 v16, v38
  ds_read_b32 v17, v38 offset:28672
  ds_read_b32 v18, v35
  ds_read_b32 v19, v35 offset:28672
  s_waitcnt lgkmcnt(0)
  v_mul_f32 v16, v16, v24
  v_mul_f32 v18, v18, v26
  v_fmac_f32 v16, v17, v25
  v_fmac_f32 v18, v19, v27
  v_add_f32 v16, v16, v18
  s_nop 1
  v_mov_b32_dpp v17, v16 quad_perm:[1,1,3,3] row_mask:0xf bank_mask:0xf
  v_cvt_pk_bf16_f32 v20, v16, v17
  s_mov_b64 exec, s[62:63]
  buffer_store_dwordx2 v[20:21], v39, s[48:51], 0 offen sc1
  s_mov_b64 exec, -1
  s_cmp_lt_u32 s3, 4
  s_cbranch_scc1 L_exit
  ds_read_b64_tr_b16 v[64:65], v44 offset:0
  ds_read_b64_tr_b16 v[66:67], v44 offset:1024
  ds_read_b64_tr_b16 v[68:69], v44 offset:8192
  ds_read_b64_tr_b16 v[70:71], v44 offset:9216
  ds_read_b64_tr_b16 v[72:73], v44 offset:128
  ds_read_b64_tr_b16 v[74:75], v44 offset:1152
  ds_read_b64_tr_b16 v[76:77], v44 offset:8320
  ds_read_b64_tr_b16 v[78:79], v44 offset:9344
  s_cmp_lg_u32 s3, 4
  s_cbranch_scc1 L_owait
  s_lshl_b32 s75, s4, 2
  s_lshr_b32 s72, s5, 3
  s_add_u32 s75, s75, s72
  s_mul_i32 s75, s75, 4352
  s_add_u32 s75, s75, 5029888
  v_min_u32 v49, 31, v0
  v_lshlrev_b32 v49, 2, v49
  s_mov_b32 s80, 0
  s_nop 0
L_oh_15:
  buffer_load_dword v48, v49, s[48:51], s75 offen sc1
  s_waitcnt vmcnt(0)
  v_cmp_ne_u32 vcc, s56, v48
  s_nop 4
  s_cbranch_vccz L_oh_ok_16
  s_add_u32 s80, s80, 1
  s_cmp_ge_u32 s80, 131072
  s_cbranch_scc1 L_oh_ok_16
  s_sleep 3
  s_branch L_oh_15
L_oh_ok_16:
  v_mov_b32 v48, 1
  ds_write_b32 v2, v48 offset:4
  s_nop 0
  s_branch L_ogo
L_owait:
L_ow_17:
  ds_read_b32 v48, v2 offset:4
  s_waitcnt lgkmcnt(0)
  v_readfirstlane_b32 s13, v48
  s_nop 1
  s_cmp_lg_u32 s13, 0
  s_nop 1
  s_cbranch_scc1 L_ogo
  s_sleep 1
  s_branch L_ow_17
L_ogo:
  s_mov_b32 s80, 0
L_opoll_18:
  buffer_load_dwordx4 v[16:19], v40, s[48:51], s76 offen sc1
  buffer_load_dwordx4 v[20:23], v40, s[48:51], s77 offen sc1
  s_waitcnt vmcnt(0)
  v_min3_u32 v48, v17, v19, v21
  v_max3_u32 v49, v17, v19, v21
  v_min3_u32 v48, v48, v23, v23
  v_max3_u32 v49, v49, v23, v23
  v_xor_b32 v48, s56, v48
  v_xor_b32 v49, s56, v49
  v_or_b32 v48, v48, v49
  v_cmp_ne_u32 vcc, 0, v48
  s_nop 4
  s_cbranch_vccz L_opoll_ok_19
  s_add_u32 s80, s80, 1
  s_cmp_ge_u32 s80, 131072
  s_cbranch_scc1 L_opoll_ok_19
  s_sleep 1
  s_branch L_opoll_18
L_opoll_ok_19:
  ds_write2_b32 v42, v16, v18 offset0:0 offset1:1
  ds_write2_b32 v42, v20, v22 offset0:128 offset1:129
  s_cmp_lg_u32 s3, 4
  s_cbranch_scc1 L_noyh
  v_mov_b32 v48, s56
  s_mov_b64 exec, 0xff
  buffer_store_dword v48, v47, s[48:51], s69 offen sc1
  s_mov_b64 exec, -1
L_noyh:
  s_waitcnt lgkmcnt(0)
  s_barrier
  ds_read_b128 v[80:83], v43 offset:0
  ds_read_b128 v[84:87], v43 offset:64
  ds_read_b128 v[88:91], v43 offset:1024
  ds_read_b128 v[92:95], v43 offset:1088
  ds_read_b128 v[96:99], v43 offset:2048
  ds_read_b128 v[100:103], v43 offset:2112
  ds_read_b128 v[104:107], v43 offset:3072
  ds_read_b128 v[108:111], v43 offset:3136
  s_waitcnt lgkmcnt(7)
  v_mfma_f32_16x16x32_bf16 v[24:27], v[80:83], v[64:67], 0
  v_mfma_f32_16x16x32_bf16 v[28:31], v[80:83], v[72:75], 0
  s_waitcnt lgkmcnt(6)
  v_mfma_f32_16x16x32_bf16 v[24:27], v[84:87], v[68:71], v[24:27]
  v_mfma_f32_16x16x32_bf16 v[28:31], v[84:87], v[76:79], v[28:31]
  s_waitcnt lgkmcnt(5)
  v_mfma_f32_16x16x32_bf16 v[24:27], v[88:91], v[64:67], v[24:27]
  v_mfma_f32_16x16x32_bf16 v[28:31], v[88:91], v[72:75], v[28:31]
  s_waitcnt lgkmcnt(4)
  v_mfma_f32_16x16x32_bf16 v[24:27], v[92:95], v[68:71], v[24:27]
  v_mfma_f32_16x16x32_bf16 v[28:31], v[92:95], v[76:79], v[28:31]
  s_waitcnt lgkmcnt(3)
  v_mfma_f32_16x16x32_bf16 v[24:27], v[96:99], v[64:67], v[24:27]
  v_mfma_f32_16x16x32_bf16 v[28:31], v[96:99], v[72:75], v[28:31]
  s_waitcnt lgkmcnt(2)
  v_mfma_f32_16x16x32_bf16 v[24:27], v[100:103], v[68:71], v[24:27]
  v_mfma_f32_16x16x32_bf16 v[28:31], v[100:103], v[76:79], v[28:31]
  s_waitcnt lgkmcnt(1)
  v_mfma_f32_16x16x32_bf16 v[24:27], v[104:107], v[64:67], v[24:27]
  v_mfma_f32_16x16x32_bf16 v[28:31], v[104:107], v[72:75], v[28:31]
  s_waitcnt lgkmcnt(0)
  v_mfma_f32_16x16x32_bf16 v[24:27], v[108:111], v[68:71], v[24:27]
  v_mfma_f32_16x16x32_bf16 v[28:31], v[108:111], v[76:79], v[28:31]
  v_mov_b32 v17, s56
  v_mov_b32 v19, s56
  v_mov_b32 v21, s56
  v_mov_b32 v23, s56
  s_nop 2
  v_cndmask_b32 v16, v24, v26, s[60:61]
  v_cndmask_b32 v18, v25, v27, s[60:61]
  v_and_or_b32 v16, v16, s59, v36
  v_and_or_b32 v18, v18, s59, v36
  buffer_store_dwordx2 v[16:17], v45, s[48:51], s79 offen sc1
  buffer_store_dwordx2 v[18:19], v46, s[48:51], s79 offen sc1
  v_cndmask_b32 v20, v28, v30, s[60:61]
  v_cndmask_b32 v22, v29, v31, s[60:61]
  v_and_or_b32 v20, v20, s59, v36
  v_and_or_b32 v22, v22, s59, v36
  s_cmp_eq_u32 s3, 7
  s_nop 0
  s_cbranch_scc1 L_ydone
  buffer_store_dwordx2 v[20:21], v45, s[48:51], s78 offen sc1
  buffer_store_dwordx2 v[22:23], v46, s[48:51], s78 offen sc1
  s_branch L_exit
L_ydone:
  s_cmp_eq_u32 s4, 7
  s_cbranch_scc1 L_fin
  s_lshl_b32 s10, s84, 13
  s_add_u32 s10, s10, 2097152
  s_add_u32 s11, s10, 4096
  s_mov_b32 s44, s32
  s_and_b32 s45, s33, 0xffff
  s_mov_b32 s46, 7168
  s_mov_b32 s47, 0x20000
  s_mul_i32 s75, s6, 4352
  s_add_u32 s75, s75, s68
  v_min_u32 v49, 63, v0
  v_lshlrev_b32 v49, 2, v49
  s_mov_b32 s80, 0
  s_nop 0
L_yh_20:
  buffer_load_dword v48, v49, s[48:51], s75 offen sc1
  s_waitcnt vmcnt(0)
  v_cmp_ne_u32 vcc, s56, v48
  s_nop 4
  s_cbranch_vccz L_yh_ok_21
  s_add_u32 s80, s80, 1
  s_cmp_ge_u32 s80, 131072
  s_cbranch_scc1 L_yh_ok_21
  s_sleep 3
  s_branch L_yh_20
L_yh_ok_21:
  s_mov_b32 s80, 0
L_ypoll_22:
  buffer_load_dwordx4 v[16:19], v7, s[48:51], s10 offen offset:0 sc1
  buffer_load_dwordx4 v[20:23], v7, s[48:51], s10 offen offset:1024 sc1
  buffer_load_dwordx4 v[24:27], v7, s[48:51], s10 offen offset:2048 sc1
  buffer_load_dwordx4 v[28:31], v7, s[48:51], s10 offen offset:3072 sc1
  buffer_load_dwordx4 v[32:35], v7, s[48:51], s11 offen offset:0 sc1
  buffer_load_dwordx4 v[36:39], v7, s[48:51], s11 offen offset:1024 sc1
  buffer_load_dwordx4 v[40:43], v7, s[48:51], s11 offen offset:2048 sc1
  buffer_load_dwordx4 v[44:47], v7, s[48:51], s11 offen offset:3072 sc1
  s_waitcnt vmcnt(0)
  v_xor_b32 v50, s56, v17
  v_xor_b32 v51, s56, v19
  v_or_b32 v48, v50, v51
  v_xor_b32 v50, s57, v16
  v_xor_b32 v51, s57, v18
  v_or_b32 v49, v50, v51
  v_xor_b32 v50, s56, v21
  v_xor_b32 v51, s56, v23
  v_or3_b32 v48, v48, v50, v51
  v_xor_b32 v50, s57, v20
  v_xor_b32 v51, s57, v22
  v_or3_b32 v49, v49, v50, v51
  v_xor_b32 v50, s56, v25
  v_xor_b32 v51, s56, v27
  v_or3_b32 v48, v48, v50, v51
  v_xor_b32 v50, s57, v24
  v_xor_b32 v51, s57, v26
  v_or3_b32 v49, v49, v50, v51
  v_xor_b32 v50, s56, v29
  v_xor_b32 v51, s56, v31
  v_or3_b32 v48, v48, v50, v51
  v_xor_b32 v50, s57, v28
  v_xor_b32 v51, s57, v30
  v_or3_b32 v49, v49, v50, v51
  v_xor_b32 v50, s56, v33
  v_xor_b32 v51, s56, v35
  v_or3_b32 v48, v48, v50, v51
  v_xor_b32 v50, s57, v32
  v_xor_b32 v51, s57, v34
  v_or3_b32 v49, v49, v50, v51
  v_xor_b32 v50, s56, v37
  v_xor_b32 v51, s56, v39
  v_or3_b32 v48, v48, v50, v51
  v_xor_b32 v50, s57, v36
  v_xor_b32 v51, s57, v38
  v_or3_b32 v49, v49, v50, v51
  v_xor_b32 v50, s56, v41
  v_xor_b32 v51, s56, v43
  v_or3_b32 v48, v48, v50, v51
  v_xor_b32 v50, s57, v40
  v_xor_b32 v51, s57, v42
  v_or3_b32 v49, v49, v50, v51
  v_xor_b32 v50, s56, v45
  v_xor_b32 v51, s56, v47
  v_or3_b32 v48, v48, v50, v51
  v_xor_b32 v50, s57, v44
  v_xor_b32 v51, s57, v46
  v_or3_b32 v49, v49, v50, v51
  v_and_b32 v49, 0xff, v49
  v_or_b32 v48, v48, v49
  v_cmp_ne_u32 vcc, 0, v48
  s_nop 4
  s_cbranch_vccz L_ypoll_ok_23
  s_add_u32 s80, s80, 1
  s_cmp_ge_u32 s80, 131072
  s_cbranch_scc1 L_ypoll_ok_23
  s_sleep 1
  s_branch L_ypoll_22
L_ypoll_ok_23:
  v_and_b32 v16, s59, v16
  v_and_b32 v18, s59, v18
  v_and_b32 v20, s59, v20
  v_and_b32 v22, s59, v22
  v_and_b32 v24, s59, v24
  v_and_b32 v26, s59, v26
  v_and_b32 v28, s59, v28
  v_and_b32 v30, s59, v30
  v_and_b32 v32, s59, v32
  v_and_b32 v34, s59, v34
  v_and_b32 v36, s59, v36
  v_and_b32 v38, s59, v38
  v_and_b32 v40, s59, v40
  v_and_b32 v42, s59, v42
  v_and_b32 v44, s59, v44
  v_and_b32 v46, s59, v46
  v_add_f32 v16, v16, v20
  v_add_f32 v24, v24, v28
  v_add_f32 v32, v32, v36
  v_add_f32 v40, v40, v44
  v_add_f32 v18, v18, v22
  v_add_f32 v26, v26, v30
  v_add_f32 v34, v34, v38
  v_add_f32 v42, v42, v46
  v_add_f32 v16, v16, v24
  v_add_f32 v32, v32, v40
  v_add_f32 v18, v18, v26
  v_add_f32 v34, v34, v42
  v_add_f32 v16, v16, v32
  v_add_f32 v18, v18, v34
  s_nop 0
  v_add_f32_dpp v16, v16, v16 row_ror:8 row_mask:0xf bank_mask:0xf
  v_add_f32_dpp v18, v18, v18 row_ror:8 row_mask:0xf bank_mask:0xf
  v_mov_b32 v8, v16
  v_mov_b32 v9, v16
  s_nop 1
  v_permlane16_swap_b32 v8, v9
  v_add_f32 v16, v8, v9
  v_mov_b32 v10, v18
  v_mov_b32 v11, v18
  s_nop 1
  v_permlane16_swap_b32 v10, v11
  v_add_f32 v18, v10, v11
  v_mov_b32 v8, v16
  v_mov_b32 v9, v16
  s_nop 1
  v_permlane32_swap_b32 v8, v9
  v_add_f32 v16, v8, v9
  v_mov_b32 v10, v18
  v_mov_b32 v11, v18
  s_nop 1
  v_permlane32_swap_b32 v10, v11
  v_add_f32 v18, v10, v11
  v_cvt_pk_bf16_f32 v16, v16, v16
  v_lshlrev_b32 v16, 16, v16
  v_cvt_pk_bf16_f32 v18, v18, v18
  v_lshlrev_b32 v18, 16, v18
  v_mul_f32 v16, v16, v14
  v_mul_f32 v18, v18, v15
  v_cvt_pk_bf16_f32 v16, v16, v16
  v_lshlrev_b32 v16, 16, v16
  v_cvt_pk_bf16_f32 v18, v18, v18
  v_lshlrev_b32 v18, 16, v18
  v_lshlrev_b32 v8, 16, v13
  v_and_b32 v9, 0xffff0000, v13
  v_add_f32 v16, v16, v8
  v_add_f32 v18, v18, v9
  v_cvt_pk_bf16_f32 v16, v16, v18
  s_mov_b64 exec, 0xff
  buffer_store_dword v16, v12, s[44:47], 0 offen
  s_mov_b64 exec, -1
  s_cmp_lg_u32 s2, 0
  s_cbranch_scc1 L_fin
  s_add_u32 s72, s38, 1
  s_add_u32 s73, s39, 1
  s_add_u32 s74, s52, 1
  s_add_u32 s75, s53, 1
  v_mov_b32 v16, s72
  v_mov_b32 v17, s73
  v_mov_b32 v18, s74
  v_mov_b32 v19, s75
  v_mov_b32 v20, 0
  v_mov_b32 v21, 6291200
  s_mov_b64 exec, 1
  buffer_store_dwordx2 v[16:17], v20, s[48:51], 0 offen
  buffer_store_dwordx2 v[18:19], v21, s[48:51], 0 offen
  s_mov_b64 exec, -1
L_fin:
L_exit:
L_end:
  s_endpgm
.section .rodata,"a"
.p2align 6
.amdhsa_kernel recurrent_scan__gqa_block_cached__dense_activation_relu__decode_kernel
  .amdhsa_next_free_vgpr 256
  .amdhsa_next_free_sgpr 102
  .amdhsa_accum_offset 256
  .amdhsa_group_segment_fixed_size 0
  .amdhsa_kernarg_size 88
  .amdhsa_user_sgpr_count 2
  .amdhsa_user_sgpr_kernarg_segment_ptr 1
  .amdhsa_system_sgpr_workgroup_id_x 1
.end_amdhsa_kernel
```
